```python
import torch

def _softmax(x, axis=-1):
    return torch.softmax(x, dim=axis)

def _gelu(x):
    return torch.nn.functional.gelu(x, approximate='tanh')

def _silu(x):
    return torch.nn.functional.silu(x)

def _sigmoid(x):
    return torch.sigmoid(x)

def _layernorm(x, axis=-1, eps=1e-05):
    m = x.mean(dim=axis, keepdim=True)
    v = x.var(dim=axis, keepdim=True, unbiased=False)
    return (x - m) / torch.sqrt(v + eps)

def _scatter_add(tgt, idx, src, axis=0):
    return tgt.clone().index_add_(axis, idx, src)

def _segment_sum(src, seg, n):
    out = torch.zeros((n,) + src.shape[1:], dtype=src.dtype)
    return out.index_add_(0, seg, src)

def _pad(x, pw):
    flat = tuple((v for pair in reversed(pw) for v in pair))
    return torch.nn.functional.pad(x, flat)
kernel_name = 'sequential_preLN__softmax_full_mha__mixer_gmlp__prompt'

def setup_inputs():

    _w = lambda a: (lambda t: t.to(torch.bfloat16) if t.is_floating_point() else t)(torch.as_tensor(a))

    def _A_setup():
        B, S, D = (1, 2048, 512)
        return {'x': _w((lambda *s: torch.randn(*s, dtype=torch.bfloat16) * 0.05)(B, S, D)), 'wqkv': _w((lambda *s: torch.randn(*s, dtype=torch.bfloat16) * 0.05)(D, 3 * D)), 'wo': _w((lambda *s: torch.randn(*s, dtype=torch.bfloat16) * 0.05)(D, D))}
    _A_in = _A_setup()

    def _B_setup():
        B, S, D, F = (1, 2048, 512, 1376)
        Fh = F // 2
        return {'x': _w((lambda *s: torch.randn(*s, dtype=torch.bfloat16) * 0.05)(B, S, D)), 'w_in': _w((lambda *s: torch.randn(*s, dtype=torch.bfloat16) * 0.4)(D, 2 * Fh)), 'w_sp': _w(0.01 * (lambda *s: torch.randn(*s, dtype=torch.bfloat16) * 0.4)(S, S)), 'b_sp': _w(1.0 + 0.01 * (lambda *s: torch.randn(*s, dtype=torch.bfloat16) * 0.05)(S)), 'w_out': _w((lambda *s: torch.randn(*s, dtype=torch.bfloat16) * 0.05)(Fh, D))}
    _B_in = _B_setup()
    return {'A_x': _A_in['x'], 'A_wqkv': _A_in['wqkv'], 'A_wo': _A_in['wo'], 'B_x': _B_in['x'], 'B_w_in': _B_in['w_in'], 'B_w_sp': _B_in['w_sp'], 'B_b_sp': _B_in['b_sp'], 'B_w_out': _B_in['w_out']}

def reference(A_x, A_wqkv, A_wo, B_x, B_w_in, B_w_sp, B_b_sp, B_w_out):

    def _A_ref(x, wqkv, wo):
        B, S, D = x.shape
        H = 32
        Dh = D // H
        qkv = (lambda x, *d: x.permute(*d))((x @ wqkv).reshape(B, S, 3, H, Dh), 2, 0, 3, 1, 4)
        q, k, v = (qkv[0], qkv[1], qkv[2])
        scale = Dh ** (-0.5)
        scores = torch.einsum('bhqd,bhkd->bhqk', q, k) * scale
        p = _softmax(scores, axis=-1)
        o = torch.einsum('bhqk,bhkd->bhqd', p, v)
        return (lambda x, *d: x.permute(*d))(o, 0, 2, 1, 3).reshape(B, S, D) @ wo

    def _B_ref(x, w_in, w_sp, b_sp, w_out):
        B, S, D = x.shape
        F = w_in.shape[-1]
        Fh = F // 2
        z = _gelu(torch.einsum('bsd,df->bsf', x, w_in))
        z1 = z[..., :Fh].clone()
        z2 = _layernorm(z[..., Fh:], axis=-1)
        g = torch.einsum('ts,bsf->btf', w_sp, z2) + b_sp[None, :, None]
        return torch.einsum('bsf,fd->bsd', z1 * g, w_out)
    x = A_x
    h = x + _A_ref(_layernorm(x, axis=-1), A_wqkv, A_wo)
    h2 = h + _B_ref(_layernorm(h, axis=-1), B_w_in, B_w_sp, B_b_sp, B_w_out)
    return h2
```

```asm
; @launch grid=(256,1,1) block=(512,1,1) lds=163840
.amdgcn_target "amdgcn-amd-amdhsa--gfx950"
.text
.globl sequential_preLN__softmax_full_mha__mixer_gmlp__prompt_kernel
.p2align 8
.type sequential_preLN__softmax_full_mha__mixer_gmlp__prompt_kernel,@function
sequential_preLN__softmax_full_mha__mixer_gmlp__prompt_kernel:
  s_cmp_ge_u32 s2, 256
  s_cbranch_scc1 L_end
  s_load_dwordx2 s[4:5], s[0:1], 0
  s_load_dwordx2 s[8:9], s[0:1], 8
  s_load_dwordx2 s[40:41], s[0:1], 80
  s_load_dwordx2 s[36:37], s[0:1], 72
  s_load_dwordx2 s[12:13], s[0:1], 16
  s_load_dwordx2 s[16:17], s[0:1], 32
  s_load_dwordx2 s[20:21], s[0:1], 40
  s_load_dwordx2 s[24:25], s[0:1], 48
  s_load_dwordx2 s[28:29], s[0:1], 56
  s_load_dwordx2 s[32:33], s[0:1], 64
  s_memrealtime s[94:95]
  v_and_b32 v1, 63, v0
  v_lshrrev_b32 v5, 6, v0
  s_getreg_b32 s51, hwreg(HW_REG_XCC_ID, 0, 4)
  v_readfirstlane_b32 s46, v5
  s_and_b32 s44, s2, 7
  s_lshr_b32 s45, s2, 3
  s_and_b32 s88, s44, 4
  s_and_b32 s89, s45, 3
  s_or_b32 s88, s88, s89
  s_lshr_b32 s90, s45, 2
  s_and_b32 s89, s44, 3
  s_lshl_b32 s89, s89, 3
  s_or_b32 s89, s89, s90
  s_mov_b32 s6, 2097152
  s_mov_b32 s7, 0x20000
  s_mov_b32 s10, 1572864
  s_mov_b32 s11, 0x20000
  s_mov_b32 s14, 524288
  s_mov_b32 s15, 0x20000
  s_mov_b32 s18, 1409024
  s_mov_b32 s19, 0x20000
  s_mov_b32 s22, 8388608
  s_mov_b32 s23, 0x20000
  s_mov_b32 s26, 4096
  s_mov_b32 s27, 0x20000
  s_mov_b32 s30, 704512
  s_mov_b32 s31, 0x20000
  s_mov_b32 s34, 2097152
  s_mov_b32 s35, 0x20000
  s_mov_b32 s38, 256
  s_mov_b32 s39, 0x20000
  s_mov_b32 s42, 17825792
  s_mov_b32 s43, 0x20000
  v_lshlrev_b32 v4, 4, v1
  v_lshrrev_b32 v5, 3, v1
  v_and_b32 v6, 7, v1
  s_lshl_b32 s64, s46, 3
  v_add_u32 v7, s64, v5
  s_lshl_b32 s65, s89, 16
  v_lshlrev_b32_e64 v8, 10, v7
  v_lshl_add_u32 v8, v6, 4, v8
  v_add_u32 v8, s65, v8
  s_mov_b32 s67, s44
  s_add_u32 s66, s67, 0
  s_and_b32 s66, s66, 7
  s_lshl_b32 s72, s66, 7
  s_add_u32 s66, s67, 1
  s_and_b32 s66, s66, 7
  s_lshl_b32 s73, s66, 7
  s_add_u32 s66, s67, 2
  s_and_b32 s66, s66, 7
  s_lshl_b32 s74, s66, 7
  s_add_u32 s66, s67, 3
  s_and_b32 s66, s66, 7
  s_lshl_b32 s75, s66, 7
  s_add_u32 s66, s67, 4
  s_and_b32 s66, s66, 7
  s_lshl_b32 s76, s66, 7
  s_add_u32 s66, s67, 5
  s_and_b32 s66, s66, 7
  s_lshl_b32 s77, s66, 7
  s_add_u32 s66, s67, 6
  s_and_b32 s66, s66, 7
  s_lshl_b32 s78, s66, 7
  s_add_u32 s66, s67, 7
  s_and_b32 s66, s66, 7
  s_lshl_b32 s79, s66, 7
  s_waitcnt lgkmcnt(0)
  s_or_b32 s64, s2, s46
  s_cmp_lg_u32 s64, 0
  s_cbranch_scc1 L_non_1
  s_or_b32 s64, s94, 0x80000000
  v_mov_b32 v9, s64
  v_mov_b32_e64 v10, 0
  s_mov_b64 exec, 1
  buffer_store_dword v9, v10, s[36:39], 0 offen sc1
  s_mov_b64 exec, -1
L_non_1:
  buffer_load_dwordx4 v[64:67], v8, s[4:7], s72 offen
  buffer_load_dwordx4 v[68:71], v8, s[4:7], s73 offen
  buffer_load_dwordx4 v[72:75], v8, s[4:7], s74 offen
  buffer_load_dwordx4 v[76:79], v8, s[4:7], s75 offen
  buffer_load_dwordx4 v[80:83], v8, s[4:7], s76 offen
  buffer_load_dwordx4 v[84:87], v8, s[4:7], s77 offen
  buffer_load_dwordx4 v[88:91], v8, s[4:7], s78 offen
  buffer_load_dwordx4 v[92:95], v8, s[4:7], s79 offen
  s_cmp_lg_u32 s46, 7
  s_cbranch_scc1 L_cpf_2
  s_getpc_b64 s[64:65]
L_pc_3:
  s_sub_u32 s64, s64, L_pc_3-sequential_preLN__softmax_full_mha__mixer_gmlp__prompt_kernel
  s_subb_u32 s65, s65, 0
  s_mul_i32 s66, s45, 13108
  s_lshr_b32 s66, s66, 16
  s_mul_i32 s66, s66, 5
  s_sub_u32 s66, s45, s66
  s_lshl_b32 s66, s66, 13
  v_lshlrev_b32 v10, 7, v1
  v_add_u32_e64 v10, s66, v10
  v_min_u32 v10, L_end-sequential_preLN__softmax_full_mha__mixer_gmlp__prompt_kernel, v10
  global_load_dword v247, v10, s[64:65]
L_cpf_2:
  s_and_b32 s48, s45, 3
  s_lshr_b32 s49, s45, 2
  s_lshl_b32 s50, s44, 2
  s_add_u32 s50, s50, s48
  s_mul_i32 s52, s49, 346431
  s_lshr_b32 s52, s52, 16
  s_lshr_b32 s53, 0xc8, s49
  s_and_b32 s53, s53, 1
  s_mov_b32 s55, 0xffff0000
  s_mov_b32 s98, 0x0000ffff
  s_mov_b32 s99, 0x0000ffff
  s_mov_b32 s47, 0
  s_mov_b32 s54, 0
  s_lshl_b32 s101, s44, 20
  s_add_u32 s101, s101, 8388608
  s_lshl_b32 s64, s49, 13
  s_lshl_b32 s65, s50, 5
  s_add_u32 s64, s64, s65
  s_add_u32 s64, s64, 27648
  v_lshlrev_b32 v2, 10, v1
  v_add_u32_e64 v2, s64, v2
  s_lshl_b32 s64, s44, 5
  s_add_u32 s64, s64, s45
  s_lshl_b32 s64, s64, 2
  v_writelane_b32 v2, s64, 13
  s_lshl_b32 s64, s88, 5
  s_add_u32 s64, s64, s89
  s_lshl_b32 s64, s64, 5
  s_add_u32 s64, s64, 4096
  v_writelane_b32 v2, s64, 0
  s_and_b32 s64, s45, 7
  s_lshl_b32 s64, s64, 5
  s_lshr_b32 s65, s45, 3
  s_add_u32 s64, s64, s65
  s_lshl_b32 s65, s44, 2
  s_add_u32 s64, s64, s65
  s_lshl_b32 s64, s64, 5
  s_add_u32 s64, s64, 24576
  v_writelane_b32 v2, s64, 1
  s_lshl_b32 s64, s50, 7
  s_lshl_b32 s65, s49, 2
  s_add_u32 s64, s64, s65
  s_add_u32 s65, s64, 12288
  v_writelane_b32 v2, s65, 2
  s_add_u32 s65, s64, 16384
  v_writelane_b32 v2, s65, 3
  s_add_u32 s65, s64, 20480
  v_writelane_b32 v2, s65, 4
  v_bfe_u32 v9, v5, 1, 1
  s_and_b32 s66, s46, 1
  s_lshl_b32 s66, s66, 1
  v_add_u32 v9, s66, v9
  v_lshlrev_b32 v9, 1, v9
  v_xor_b32 v9, v9, v6
  v_lshlrev_b32_e64 v9, 4, v9
  v_mul_u32_u24 v10, 3072, v7
  v_add_u32 v9, v9, v10
  s_lshl_b32 s66, s88, 7
  v_add_u32 v9, s66, v9
  s_lshl_b32 s56, s46, 10
  s_add_u32 s56, s56, 65536
  s_cmp_lt_u32 s46, 4
  s_mov_b32 s67, -98304
  s_cselect_b32 s66, 98304, s67
  v_add_u32 v39, s66, v9
  s_mov_b32 s67, -4096
  s_cselect_b32 s66, 4096, s67
  s_add_u32 s58, s56, s66
  v_and_b32 v10, 7, v7
  v_xor_b32 v10, v10, v6
  v_lshlrev_b32 v10, 4, v10
  v_and_b32_e64 v5, 8, v7
  v_lshl_add_u32 v10, v5, 4, v10
  v_lshl_add_u32 v10, v7, 10, v10
  v_and_b32 v5, 15, v1
  v_lshrrev_b32 v6, 4, v1
  s_and_b32 s66, s46, 1
  s_lshl_b32 s66, s66, 15
  v_xor_b32 v13, v5, v6
  v_lshlrev_b32 v13, 4, v13
  v_lshl_add_u32 v13, v5, 10, v13
  v_add_u32_e64 v13, s66, v13
  v_bfe_u32 v7, v5, 3, 1
  v_and_b32_e64 v11, 1, v6
  v_lshl_add_u32 v7, v11, 1, v7
  v_lshlrev_b32_e64 v7, 1, v7
  v_bfe_u32 v11, v5, 1, 1
  s_and_b32 s66, s46, 6
  v_add_u32 v11, s66, v11
  v_xor_b32 v11, v11, v7
  v_lshlrev_b32 v11, 4, v11
  v_and_b32_e64 v7, 1, v5
  v_lshl_add_u32 v11, v7, 3, v11
  v_lshrrev_b32_e64 v7, 2, v5
  v_lshl_add_u32 v11, v7, 7, v11
  v_lshl_add_u32 v11, v6, 10, v11
  v_add_u32 v11, 65536, v11
  v_add_u32 v12, 49152, v11
  v_readlane_b32 s66, v2, 13
  s_cmp_eq_u32 s46, 0
  s_cselect_b32 s66, s66, 0x7ffff000
  v_mov_b32 v8, s66
  v_mov_b32 v40, 0
  v_mov_b32 v41, 0
  v_mov_b32 v48, 0x3f803f80
  s_waitcnt vmcnt(7)
  v_dot2c_f32_bf16 v40, v64, v48
  v_dot2c_f32_bf16 v41, v64, v64
  v_dot2c_f32_bf16 v40, v65, v48
  v_dot2c_f32_bf16 v41, v65, v65
  v_dot2c_f32_bf16 v40, v66, v48
  v_dot2c_f32_bf16 v41, v66, v66
  v_dot2c_f32_bf16 v40, v67, v48
  v_dot2c_f32_bf16 v41, v67, v67
  s_waitcnt vmcnt(6)
  v_dot2c_f32_bf16 v40, v68, v48
  v_dot2c_f32_bf16 v41, v68, v68
  v_dot2c_f32_bf16 v40, v69, v48
  v_dot2c_f32_bf16 v41, v69, v69
  v_dot2c_f32_bf16 v40, v70, v48
  v_dot2c_f32_bf16 v41, v70, v70
  v_dot2c_f32_bf16 v40, v71, v48
  v_dot2c_f32_bf16 v41, v71, v71
  s_waitcnt vmcnt(5)
  v_dot2c_f32_bf16 v40, v72, v48
  v_dot2c_f32_bf16 v41, v72, v72
  v_dot2c_f32_bf16 v40, v73, v48
  v_dot2c_f32_bf16 v41, v73, v73
  v_dot2c_f32_bf16 v40, v74, v48
  v_dot2c_f32_bf16 v41, v74, v74
  v_dot2c_f32_bf16 v40, v75, v48
  v_dot2c_f32_bf16 v41, v75, v75
  s_waitcnt vmcnt(4)
  v_dot2c_f32_bf16 v40, v76, v48
  v_dot2c_f32_bf16 v41, v76, v76
  v_dot2c_f32_bf16 v40, v77, v48
  v_dot2c_f32_bf16 v41, v77, v77
  v_dot2c_f32_bf16 v40, v78, v48
  v_dot2c_f32_bf16 v41, v78, v78
  v_dot2c_f32_bf16 v40, v79, v48
  v_dot2c_f32_bf16 v41, v79, v79
  s_waitcnt vmcnt(3)
  v_dot2c_f32_bf16 v40, v80, v48
  v_dot2c_f32_bf16 v41, v80, v80
  v_dot2c_f32_bf16 v40, v81, v48
  v_dot2c_f32_bf16 v41, v81, v81
  v_dot2c_f32_bf16 v40, v82, v48
  v_dot2c_f32_bf16 v41, v82, v82
  v_dot2c_f32_bf16 v40, v83, v48
  v_dot2c_f32_bf16 v41, v83, v83
  s_waitcnt vmcnt(2)
  v_dot2c_f32_bf16 v40, v84, v48
  v_dot2c_f32_bf16 v41, v84, v84
  v_dot2c_f32_bf16 v40, v85, v48
  v_dot2c_f32_bf16 v41, v85, v85
  v_dot2c_f32_bf16 v40, v86, v48
  v_dot2c_f32_bf16 v41, v86, v86
  v_dot2c_f32_bf16 v40, v87, v48
  v_dot2c_f32_bf16 v41, v87, v87
  s_waitcnt vmcnt(1)
  v_dot2c_f32_bf16 v40, v88, v48
  v_dot2c_f32_bf16 v41, v88, v88
  v_dot2c_f32_bf16 v40, v89, v48
  v_dot2c_f32_bf16 v41, v89, v89
  v_dot2c_f32_bf16 v40, v90, v48
  v_dot2c_f32_bf16 v41, v90, v90
  v_dot2c_f32_bf16 v40, v91, v48
  v_dot2c_f32_bf16 v41, v91, v91
  s_waitcnt vmcnt(0)
  v_dot2c_f32_bf16 v40, v92, v48
  v_dot2c_f32_bf16 v41, v92, v92
  v_dot2c_f32_bf16 v40, v93, v48
  v_dot2c_f32_bf16 v41, v93, v93
  v_dot2c_f32_bf16 v40, v94, v48
  v_dot2c_f32_bf16 v41, v94, v94
  v_dot2c_f32_bf16 v40, v95, v48
  v_dot2c_f32_bf16 v41, v95, v95
  v_mov_b32_e64 v46, 0
  s_cmp_lg_u32 s46, 0
  s_cbranch_scc1 L_w0_4
  buffer_load_dword v3, v46, s[36:39], 0 offen sc1
L_w0_4:
  s_cmp_ge_u32 s46, 4
  s_cbranch_scc1 L_hi_5
  s_add_u32 s57, s90, 0
  s_and_b32 s57, s57, 7
  s_mul_i32 s57, s57, 196608
  s_add_u32 m0, s56, 0
  s_nop 0
  buffer_load_dwordx4 v9, s[8:11], s57 offen lds
  s_add_u32 m0, s58, 0
  s_nop 0
  buffer_load_dwordx4 v39, s[8:11], s57 offen lds
  s_add_u32 s57, s57, 1024
  s_add_u32 m0, s56, 8192
  s_nop 0
  buffer_load_dwordx4 v9, s[8:11], s57 offen lds
  s_add_u32 m0, s58, 8192
  s_nop 0
  buffer_load_dwordx4 v39, s[8:11], s57 offen lds
  s_add_u32 s57, s57, 1024
  s_add_u32 m0, s56, 16384
  s_nop 0
  buffer_load_dwordx4 v9, s[8:11], s57 offen lds
  s_add_u32 m0, s58, 16384
  s_nop 0
  buffer_load_dwordx4 v39, s[8:11], s57 offen lds
  v_add_f32_dpp v40, v40, v40 quad_perm:[1,0,3,2] row_mask:0xf bank_mask:0xf
  v_add_f32_dpp v41, v41, v41 quad_perm:[1,0,3,2] row_mask:0xf bank_mask:0xf
  s_nop 0
  v_add_f32_dpp v40, v40, v40 quad_perm:[2,3,0,1] row_mask:0xf bank_mask:0xf
  v_add_f32_dpp v41, v41, v41 quad_perm:[2,3,0,1] row_mask:0xf bank_mask:0xf
  s_nop 0
  v_add_f32_dpp v40, v40, v40 row_half_mirror row_mask:0xf bank_mask:0xf
  v_add_f32_dpp v41, v41, v41 row_half_mirror row_mask:0xf bank_mask:0xf
  v_mul_f32 v40, 0x3b000000, v40
  v_mul_f32 v41, 0x3b000000, v41
  v_fma_f32 v41, -v40, v40, v41
  v_max_f32_e64 v41, 0, v41
  v_add_f32 v41, 0x3727c5ac, v41
  v_rsq_f32 v42, v41
  v_sub_f32 v40, 0, v40
  v_mul_f32 v44, v40, v42
  v_mov_b32 v43, v42
  v_mov_b32 v45, v44
  v_lshlrev_b32 v48, 16, v64
  v_and_b32 v49, s55, v64
  v_lshlrev_b32 v50, 16, v65
  v_and_b32 v51, s55, v65
  v_lshlrev_b32 v52, 16, v66
  v_and_b32 v53, s55, v66
  v_lshlrev_b32 v54, 16, v67
  v_and_b32_e64 v55, s55, v67
  v_pk_fma_f32 v[48:49], v[48:49], v[42:43], v[44:45]
  v_pk_fma_f32 v[50:51], v[50:51], v[42:43], v[44:45]
  v_pk_fma_f32 v[52:53], v[52:53], v[42:43], v[44:45]
  v_pk_fma_f32 v[54:55], v[54:55], v[42:43], v[44:45]
  v_cvt_pk_bf16_f32 v64, v48, v49
  v_cvt_pk_bf16_f32 v65, v50, v51
  v_cvt_pk_bf16_f32 v66, v52, v53
  v_cvt_pk_bf16_f32 v67, v54, v55
  v_xor_b32_e64 v5, s72, v10
  ds_write_b128 v5, v[64:67]
  s_add_u32 s57, s90, 1
  s_and_b32 s57, s57, 7
  s_mul_i32 s57, s57, 196608
  s_add_u32 m0, s56, 24576
  s_nop 0
  buffer_load_dwordx4 v9, s[8:11], s57 offen lds
  s_add_u32 m0, s58, 24576
  s_nop 0
  buffer_load_dwordx4 v39, s[8:11], s57 offen lds
  v_lshlrev_b32 v48, 16, v68
  v_and_b32 v49, s55, v68
  v_lshlrev_b32 v50, 16, v69
  v_and_b32 v51, s55, v69
  v_lshlrev_b32 v52, 16, v70
  v_and_b32 v53, s55, v70
  v_lshlrev_b32 v54, 16, v71
  v_and_b32 v55, s55, v71
  v_pk_fma_f32 v[48:49], v[48:49], v[42:43], v[44:45]
  v_pk_fma_f32 v[50:51], v[50:51], v[42:43], v[44:45]
  v_pk_fma_f32 v[52:53], v[52:53], v[42:43], v[44:45]
  v_pk_fma_f32 v[54:55], v[54:55], v[42:43], v[44:45]
  v_cvt_pk_bf16_f32 v68, v48, v49
  v_cvt_pk_bf16_f32 v69, v50, v51
  v_cvt_pk_bf16_f32 v70, v52, v53
  v_cvt_pk_bf16_f32 v71, v54, v55
  v_xor_b32_e64 v5, s73, v10
  ds_write_b128 v5, v[68:71]
  v_lshlrev_b32 v48, 16, v72
  v_and_b32 v49, s55, v72
  v_lshlrev_b32 v50, 16, v73
  v_and_b32 v51, s55, v73
  v_lshlrev_b32 v52, 16, v74
  v_and_b32 v53, s55, v74
  v_lshlrev_b32 v54, 16, v75
  v_and_b32 v55, s55, v75
  v_pk_fma_f32 v[48:49], v[48:49], v[42:43], v[44:45]
  v_pk_fma_f32 v[50:51], v[50:51], v[42:43], v[44:45]
  v_pk_fma_f32 v[52:53], v[52:53], v[42:43], v[44:45]
  v_pk_fma_f32 v[54:55], v[54:55], v[42:43], v[44:45]
  v_cvt_pk_bf16_f32 v72, v48, v49
  v_cvt_pk_bf16_f32 v73, v50, v51
  v_cvt_pk_bf16_f32 v74, v52, v53
  v_cvt_pk_bf16_f32 v75, v54, v55
  v_xor_b32_e64 v5, s74, v10
  ds_write_b128 v5, v[72:75]
  s_add_u32 s57, s57, 1024
  s_add_u32 m0, s56, 32768
  s_nop 0
  buffer_load_dwordx4 v9, s[8:11], s57 offen lds
  s_add_u32 m0, s58, 32768
  s_nop 0
  buffer_load_dwordx4 v39, s[8:11], s57 offen lds
  v_lshlrev_b32 v48, 16, v76
  v_and_b32 v49, s55, v76
  v_lshlrev_b32 v50, 16, v77
  v_and_b32 v51, s55, v77
  v_lshlrev_b32 v52, 16, v78
  v_and_b32 v53, s55, v78
  v_lshlrev_b32 v54, 16, v79
  v_and_b32 v55, s55, v79
  v_pk_fma_f32 v[48:49], v[48:49], v[42:43], v[44:45]
  v_pk_fma_f32 v[50:51], v[50:51], v[42:43], v[44:45]
  v_pk_fma_f32 v[52:53], v[52:53], v[42:43], v[44:45]
  v_pk_fma_f32 v[54:55], v[54:55], v[42:43], v[44:45]
  v_cvt_pk_bf16_f32 v76, v48, v49
  v_cvt_pk_bf16_f32 v77, v50, v51
  v_cvt_pk_bf16_f32 v78, v52, v53
  v_cvt_pk_bf16_f32 v79, v54, v55
  v_xor_b32_e64 v5, s75, v10
  ds_write_b128 v5, v[76:79]
  v_lshlrev_b32 v48, 16, v80
  v_and_b32 v49, s55, v80
  v_lshlrev_b32 v50, 16, v81
  v_and_b32 v51, s55, v81
  v_lshlrev_b32 v52, 16, v82
  v_and_b32 v53, s55, v82
  v_lshlrev_b32 v54, 16, v83
  v_and_b32 v55, s55, v83
  v_pk_fma_f32 v[48:49], v[48:49], v[42:43], v[44:45]
  v_pk_fma_f32 v[50:51], v[50:51], v[42:43], v[44:45]
  v_pk_fma_f32 v[52:53], v[52:53], v[42:43], v[44:45]
  v_pk_fma_f32 v[54:55], v[54:55], v[42:43], v[44:45]
  v_cvt_pk_bf16_f32 v80, v48, v49
  v_cvt_pk_bf16_f32 v81, v50, v51
  v_cvt_pk_bf16_f32 v82, v52, v53
  v_cvt_pk_bf16_f32 v83, v54, v55
  v_xor_b32_e64 v5, s76, v10
  ds_write_b128 v5, v[80:83]
  v_lshlrev_b32 v48, 16, v84
  v_and_b32 v49, s55, v84
  v_lshlrev_b32 v50, 16, v85
  v_and_b32 v51, s55, v85
  v_lshlrev_b32 v52, 16, v86
  v_and_b32 v53, s55, v86
  v_lshlrev_b32 v54, 16, v87
  v_and_b32 v55, s55, v87
  v_pk_fma_f32 v[48:49], v[48:49], v[42:43], v[44:45]
  v_pk_fma_f32 v[50:51], v[50:51], v[42:43], v[44:45]
  v_pk_fma_f32 v[52:53], v[52:53], v[42:43], v[44:45]
  v_pk_fma_f32 v[54:55], v[54:55], v[42:43], v[44:45]
  v_cvt_pk_bf16_f32 v84, v48, v49
  v_cvt_pk_bf16_f32 v85, v50, v51
  v_cvt_pk_bf16_f32 v86, v52, v53
  v_cvt_pk_bf16_f32 v87, v54, v55
  v_xor_b32_e64 v5, s77, v10
  ds_write_b128 v5, v[84:87]
  s_add_u32 s57, s57, 1024
  s_add_u32 m0, s56, 40960
  s_nop 0
  buffer_load_dwordx4 v9, s[8:11], s57 offen lds
  s_add_u32 m0, s58, 40960
  s_nop 0
  buffer_load_dwordx4 v39, s[8:11], s57 offen lds
  v_lshlrev_b32 v48, 16, v88
  v_and_b32 v49, s55, v88
  v_lshlrev_b32 v50, 16, v89
  v_and_b32 v51, s55, v89
  v_lshlrev_b32 v52, 16, v90
  v_and_b32 v53, s55, v90
  v_lshlrev_b32 v54, 16, v91
  v_and_b32 v55, s55, v91
  v_pk_fma_f32 v[48:49], v[48:49], v[42:43], v[44:45]
  v_pk_fma_f32 v[50:51], v[50:51], v[42:43], v[44:45]
  v_pk_fma_f32 v[52:53], v[52:53], v[42:43], v[44:45]
  v_pk_fma_f32 v[54:55], v[54:55], v[42:43], v[44:45]
  v_cvt_pk_bf16_f32 v88, v48, v49
  v_cvt_pk_bf16_f32 v89, v50, v51
  v_cvt_pk_bf16_f32 v90, v52, v53
  v_cvt_pk_bf16_f32 v91, v54, v55
  v_xor_b32_e64 v5, s78, v10
  ds_write_b128 v5, v[88:91]
  v_lshlrev_b32 v48, 16, v92
  v_and_b32 v49, s55, v92
  v_lshlrev_b32 v50, 16, v93
  v_and_b32 v51, s55, v93
  v_lshlrev_b32 v52, 16, v94
  v_and_b32 v53, s55, v94
  v_lshlrev_b32 v54, 16, v95
  v_and_b32 v55, s55, v95
  v_pk_fma_f32 v[48:49], v[48:49], v[42:43], v[44:45]
  v_pk_fma_f32 v[50:51], v[50:51], v[42:43], v[44:45]
  v_pk_fma_f32 v[52:53], v[52:53], v[42:43], v[44:45]
  v_pk_fma_f32 v[54:55], v[54:55], v[42:43], v[44:45]
  v_cvt_pk_bf16_f32 v92, v48, v49
  v_cvt_pk_bf16_f32 v93, v50, v51
  v_cvt_pk_bf16_f32 v94, v52, v53
  v_cvt_pk_bf16_f32 v95, v54, v55
  v_xor_b32_e64 v5, s79, v10
  ds_write_b128 v5, v[92:95]
  s_waitcnt vmcnt(6)
  s_branch L_hd_6
L_hi_5:
  v_add_f32_dpp v40, v40, v40 quad_perm:[1,0,3,2] row_mask:0xf bank_mask:0xf
  v_add_f32_dpp v41, v41, v41 quad_perm:[1,0,3,2] row_mask:0xf bank_mask:0xf
  s_nop 0
  v_add_f32_dpp v40, v40, v40 quad_perm:[2,3,0,1] row_mask:0xf bank_mask:0xf
  v_add_f32_dpp v41, v41, v41 quad_perm:[2,3,0,1] row_mask:0xf bank_mask:0xf
  s_nop 0
  v_add_f32_dpp v40, v40, v40 row_half_mirror row_mask:0xf bank_mask:0xf
  v_add_f32_dpp v41, v41, v41 row_half_mirror row_mask:0xf bank_mask:0xf
  v_mul_f32 v40, 0x3b000000, v40
  v_mul_f32 v41, 0x3b000000, v41
  v_fma_f32 v41, -v40, v40, v41
  v_max_f32_e64 v41, 0, v41
  v_add_f32 v41, 0x3727c5ac, v41
  v_rsq_f32 v42, v41
  v_sub_f32 v40, 0, v40
  v_mul_f32 v44, v40, v42
  v_mov_b32 v43, v42
  v_mov_b32 v45, v44
  s_setprio 1
  v_lshlrev_b32 v48, 16, v64
  v_and_b32 v49, s55, v64
  v_lshlrev_b32 v50, 16, v65
  v_and_b32 v51, s55, v65
  v_lshlrev_b32 v52, 16, v66
  v_and_b32 v53, s55, v66
  v_lshlrev_b32 v54, 16, v67
  v_and_b32 v55, s55, v67
  v_pk_fma_f32 v[48:49], v[48:49], v[42:43], v[44:45]
  v_pk_fma_f32 v[50:51], v[50:51], v[42:43], v[44:45]
  v_pk_fma_f32 v[52:53], v[52:53], v[42:43], v[44:45]
  v_pk_fma_f32 v[54:55], v[54:55], v[42:43], v[44:45]
  v_cvt_pk_bf16_f32 v64, v48, v49
  v_cvt_pk_bf16_f32 v65, v50, v51
  v_cvt_pk_bf16_f32 v66, v52, v53
  v_cvt_pk_bf16_f32 v67, v54, v55
  v_xor_b32_e64 v5, s72, v10
  ds_write_b128 v5, v[64:67]
  v_lshlrev_b32 v48, 16, v68
  v_and_b32 v49, s55, v68
  v_lshlrev_b32 v50, 16, v69
  v_and_b32 v51, s55, v69
  v_lshlrev_b32 v52, 16, v70
  v_and_b32 v53, s55, v70
  v_lshlrev_b32 v54, 16, v71
  v_and_b32 v55, s55, v71
  v_pk_fma_f32 v[48:49], v[48:49], v[42:43], v[44:45]
  v_pk_fma_f32 v[50:51], v[50:51], v[42:43], v[44:45]
  v_pk_fma_f32 v[52:53], v[52:53], v[42:43], v[44:45]
  v_pk_fma_f32 v[54:55], v[54:55], v[42:43], v[44:45]
  v_cvt_pk_bf16_f32 v68, v48, v49
  v_cvt_pk_bf16_f32 v69, v50, v51
  v_cvt_pk_bf16_f32 v70, v52, v53
  v_cvt_pk_bf16_f32 v71, v54, v55
  v_xor_b32_e64 v5, s73, v10
  ds_write_b128 v5, v[68:71]
  v_lshlrev_b32 v48, 16, v72
  v_and_b32 v49, s55, v72
  v_lshlrev_b32 v50, 16, v73
  v_and_b32 v51, s55, v73
  v_lshlrev_b32 v52, 16, v74
  v_and_b32 v53, s55, v74
  v_lshlrev_b32 v54, 16, v75
  v_and_b32 v55, s55, v75
  v_pk_fma_f32 v[48:49], v[48:49], v[42:43], v[44:45]
  v_pk_fma_f32 v[50:51], v[50:51], v[42:43], v[44:45]
  v_pk_fma_f32 v[52:53], v[52:53], v[42:43], v[44:45]
  v_pk_fma_f32 v[54:55], v[54:55], v[42:43], v[44:45]
  v_cvt_pk_bf16_f32 v72, v48, v49
  v_cvt_pk_bf16_f32 v73, v50, v51
  v_cvt_pk_bf16_f32 v74, v52, v53
  v_cvt_pk_bf16_f32 v75, v54, v55
  v_xor_b32_e64 v5, s74, v10
  ds_write_b128 v5, v[72:75]
  v_lshlrev_b32 v48, 16, v76
  v_and_b32 v49, s55, v76
  v_lshlrev_b32 v50, 16, v77
  v_and_b32 v51, s55, v77
  v_lshlrev_b32 v52, 16, v78
  v_and_b32 v53, s55, v78
  v_lshlrev_b32 v54, 16, v79
  v_and_b32 v55, s55, v79
  v_pk_fma_f32 v[48:49], v[48:49], v[42:43], v[44:45]
  v_pk_fma_f32 v[50:51], v[50:51], v[42:43], v[44:45]
  v_pk_fma_f32 v[52:53], v[52:53], v[42:43], v[44:45]
  v_pk_fma_f32 v[54:55], v[54:55], v[42:43], v[44:45]
  v_cvt_pk_bf16_f32 v76, v48, v49
  v_cvt_pk_bf16_f32 v77, v50, v51
  v_cvt_pk_bf16_f32 v78, v52, v53
  v_cvt_pk_bf16_f32 v79, v54, v55
  v_xor_b32_e64 v5, s75, v10
  ds_write_b128 v5, v[76:79]
  v_lshlrev_b32 v48, 16, v80
  v_and_b32 v49, s55, v80
  v_lshlrev_b32 v50, 16, v81
  v_and_b32 v51, s55, v81
  v_lshlrev_b32 v52, 16, v82
  v_and_b32 v53, s55, v82
  v_lshlrev_b32 v54, 16, v83
  v_and_b32 v55, s55, v83
  v_pk_fma_f32 v[48:49], v[48:49], v[42:43], v[44:45]
  v_pk_fma_f32 v[50:51], v[50:51], v[42:43], v[44:45]
  v_pk_fma_f32 v[52:53], v[52:53], v[42:43], v[44:45]
  v_pk_fma_f32 v[54:55], v[54:55], v[42:43], v[44:45]
  v_cvt_pk_bf16_f32 v80, v48, v49
  v_cvt_pk_bf16_f32 v81, v50, v51
  v_cvt_pk_bf16_f32 v82, v52, v53
  v_cvt_pk_bf16_f32 v83, v54, v55
  v_xor_b32_e64 v5, s76, v10
  ds_write_b128 v5, v[80:83]
  v_lshlrev_b32 v48, 16, v84
  v_and_b32 v49, s55, v84
  v_lshlrev_b32 v50, 16, v85
  v_and_b32 v51, s55, v85
  v_lshlrev_b32 v52, 16, v86
  v_and_b32 v53, s55, v86
  v_lshlrev_b32 v54, 16, v87
  v_and_b32 v55, s55, v87
  v_pk_fma_f32 v[48:49], v[48:49], v[42:43], v[44:45]
  v_pk_fma_f32 v[50:51], v[50:51], v[42:43], v[44:45]
  v_pk_fma_f32 v[52:53], v[52:53], v[42:43], v[44:45]
  v_pk_fma_f32 v[54:55], v[54:55], v[42:43], v[44:45]
  v_cvt_pk_bf16_f32 v84, v48, v49
  v_cvt_pk_bf16_f32 v85, v50, v51
  v_cvt_pk_bf16_f32 v86, v52, v53
  v_cvt_pk_bf16_f32 v87, v54, v55
  v_xor_b32_e64 v5, s77, v10
  ds_write_b128 v5, v[84:87]
  v_lshlrev_b32 v48, 16, v88
  v_and_b32 v49, s55, v88
  v_lshlrev_b32 v50, 16, v89
  v_and_b32 v51, s55, v89
  v_lshlrev_b32 v52, 16, v90
  v_and_b32 v53, s55, v90
  v_lshlrev_b32 v54, 16, v91
  v_and_b32 v55, s55, v91
  v_pk_fma_f32 v[48:49], v[48:49], v[42:43], v[44:45]
  v_pk_fma_f32 v[50:51], v[50:51], v[42:43], v[44:45]
  v_pk_fma_f32 v[52:53], v[52:53], v[42:43], v[44:45]
  v_pk_fma_f32 v[54:55], v[54:55], v[42:43], v[44:45]
  v_cvt_pk_bf16_f32 v88, v48, v49
  v_cvt_pk_bf16_f32 v89, v50, v51
  v_cvt_pk_bf16_f32 v90, v52, v53
  v_cvt_pk_bf16_f32 v91, v54, v55
  v_xor_b32_e64 v5, s78, v10
  ds_write_b128 v5, v[88:91]
  v_lshlrev_b32 v48, 16, v92
  v_and_b32 v49, s55, v92
  v_lshlrev_b32 v50, 16, v93
  v_and_b32 v51, s55, v93
  v_lshlrev_b32 v52, 16, v94
  v_and_b32 v53, s55, v94
  v_lshlrev_b32 v54, 16, v95
  v_and_b32 v55, s55, v95
  v_pk_fma_f32 v[48:49], v[48:49], v[42:43], v[44:45]
  v_pk_fma_f32 v[50:51], v[50:51], v[42:43], v[44:45]
  v_pk_fma_f32 v[52:53], v[52:53], v[42:43], v[44:45]
  v_pk_fma_f32 v[54:55], v[54:55], v[42:43], v[44:45]
  v_cvt_pk_bf16_f32 v92, v48, v49
  v_cvt_pk_bf16_f32 v93, v50, v51
  v_cvt_pk_bf16_f32 v94, v52, v53
  v_cvt_pk_bf16_f32 v95, v54, v55
  v_xor_b32_e64 v5, s79, v10
  ds_write_b128 v5, v[92:95]
  s_setprio 0
L_hd_6:
  s_lshr_b32 s64, s46, 1
  s_lshl_b32 s64, s64, 6
  s_lshl_b32 s65, s89, 1
  s_add_u32 s64, s64, s65
  s_and_b32 s65, s46, 1
  s_add_u32 s64, s64, s65
  s_lshl_b32 s70, s88, 20
  s_add_u32 s70, s70, 8388608
  s_lshl_b32 s69, s64, 8
  s_add_u32 s69, s69, s70
  s_add_u32 s69, s69, 786432
  s_lshl_b32 s64, s64, 10
  s_add_u32 s65, s64, s70
  s_waitcnt lgkmcnt(0)
  s_barrier
  s_add_u32 s67, s90, 0
  s_and_b32 s67, s67, 7
  s_lshl_b32 s67, s67, 7
  v_xor_b32 v14, s67, v13
  ds_read_b128 v[96:99], v14 offset:0
  ds_read_b64_tr_b16 v[104:105], v11 offset:0
  ds_read_b64_tr_b16 v[106:107], v11 offset:512
  ds_read_b128 v[100:103], v14 offset:16384
  ds_read_b64_tr_b16 v[108:109], v11 offset:8192
  ds_read_b64_tr_b16 v[110:111], v11 offset:8704
  ds_read_b64_tr_b16 v[112:113], v11 offset:16384
  ds_read_b64_tr_b16 v[114:115], v11 offset:16896
  v_xor_b32_e64 v15, 64, v14
  ds_read_b128 v[116:119], v15 offset:0
  ds_read_b64_tr_b16 v[124:125], v11 offset:4096
  ds_read_b64_tr_b16 v[126:127], v11 offset:4608
  ds_read_b128 v[120:123], v15 offset:16384
  ds_read_b64_tr_b16 v[128:129], v11 offset:12288
  ds_read_b64_tr_b16 v[130:131], v11 offset:12800
  ds_read_b64_tr_b16 v[132:133], v11 offset:20480
  ds_read_b64_tr_b16 v[134:135], v11 offset:20992
  s_waitcnt lgkmcnt(8)
  v_mfma_f32_16x16x32_bf16 v[16:19], v[104:107], v[96:99], 0
  s_cmp_ge_u32 s46, 4
  s_cbranch_scc1 L_ho_7
  s_add_u32 s57, s90, 2
  s_and_b32 s57, s57, 7
  s_mul_i32 s57, s57, 196608
  s_add_u32 m0, s56, 49152
  s_nop 0
  buffer_load_dwordx4 v9, s[8:11], s57 offen lds
  s_add_u32 s57, s57, 1024
  s_add_u32 m0, s56, 57344
  s_nop 0
  buffer_load_dwordx4 v9, s[8:11], s57 offen lds
  s_add_u32 s57, s57, 1024
  s_add_u32 m0, s56, 65536
  s_nop 0
  buffer_load_dwordx4 v9, s[8:11], s57 offen lds
  s_add_u32 s57, s90, 3
  s_and_b32 s57, s57, 7
  s_mul_i32 s57, s57, 196608
  s_add_u32 m0, s56, 73728
  s_nop 0
  buffer_load_dwordx4 v9, s[8:11], s57 offen lds
  s_add_u32 s57, s57, 1024
  s_add_u32 m0, s56, 81920
  s_nop 0
  buffer_load_dwordx4 v9, s[8:11], s57 offen lds
  s_add_u32 s57, s57, 1024
  s_add_u32 m0, s56, 90112
  s_nop 0
  buffer_load_dwordx4 v9, s[8:11], s57 offen lds
L_ho_7:
  v_mfma_f32_16x16x32_bf16 v[20:23], v[104:107], v[100:103], 0
  v_mfma_f32_16x16x32_bf16 v[24:27], v[108:111], v[96:99], 0
  v_mfma_f32_16x16x32_bf16 v[28:31], v[108:111], v[100:103], 0
  v_mfma_f32_16x16x32_bf16 v[32:35], v[96:99], v[112:115], 0
  v_mfma_f32_16x16x32_bf16 v[36:39], v[100:103], v[112:115], 0
  s_waitcnt vmcnt(6)
  s_barrier
  s_waitcnt lgkmcnt(0)
  v_mfma_f32_16x16x32_bf16 v[16:19], v[124:127], v[116:119], v[16:19]
  s_add_u32 s67, s90, 1
  s_and_b32 s67, s67, 7
  s_lshl_b32 s67, s67, 7
  v_xor_b32 v14, s67, v13
  s_cmp_lt_u32 s46, 4
  s_cbranch_scc1 L_ho_8
  s_add_u32 s57, s90, 2
  s_and_b32 s57, s57, 7
  s_mul_i32 s57, s57, 196608
  s_add_u32 m0, s56, 49152
  s_nop 0
  buffer_load_dwordx4 v9, s[8:11], s57 offen lds
  s_add_u32 s57, s57, 1024
  s_add_u32 m0, s56, 57344
  s_nop 0
  buffer_load_dwordx4 v9, s[8:11], s57 offen lds
  s_add_u32 s57, s57, 1024
  s_add_u32 m0, s56, 65536
  s_nop 0
  buffer_load_dwordx4 v9, s[8:11], s57 offen lds
  s_add_u32 s57, s90, 3
  s_and_b32 s57, s57, 7
  s_mul_i32 s57, s57, 196608
  s_add_u32 m0, s56, 73728
  s_nop 0
  buffer_load_dwordx4 v9, s[8:11], s57 offen lds
  s_add_u32 s57, s57, 1024
  s_add_u32 m0, s56, 81920
  s_nop 0
  buffer_load_dwordx4 v9, s[8:11], s57 offen lds
  s_add_u32 s57, s57, 1024
  s_add_u32 m0, s56, 90112
  s_nop 0
  buffer_load_dwordx4 v9, s[8:11], s57 offen lds
L_ho_8:
  ds_read_b128 v[136:139], v14 offset:0
  ds_read_b64_tr_b16 v[144:145], v11 offset:24576
  v_mfma_f32_16x16x32_bf16 v[20:23], v[124:127], v[120:123], v[20:23]
  ds_read_b64_tr_b16 v[146:147], v11 offset:25088
  ds_read_b128 v[140:143], v14 offset:16384
  ds_read_b64_tr_b16 v[148:149], v11 offset:32768
  v_mfma_f32_16x16x32_bf16 v[24:27], v[128:131], v[116:119], v[24:27]
  ds_read_b64_tr_b16 v[150:151], v11 offset:33280
  ds_read_b64_tr_b16 v[152:153], v11 offset:40960
  ds_read_b64_tr_b16 v[154:155], v11 offset:41472
  v_mfma_f32_16x16x32_bf16 v[28:31], v[128:131], v[120:123], v[28:31]
  v_xor_b32_e64 v15, 64, v14
  ds_read_b128 v[96:99], v15 offset:0
  ds_read_b64_tr_b16 v[104:105], v11 offset:28672
  v_mfma_f32_16x16x32_bf16 v[32:35], v[116:119], v[132:135], v[32:35]
  ds_read_b64_tr_b16 v[106:107], v11 offset:29184
  ds_read_b128 v[100:103], v15 offset:16384
  ds_read_b64_tr_b16 v[108:109], v11 offset:36864
  v_mfma_f32_16x16x32_bf16 v[36:39], v[120:123], v[132:135], v[36:39]
  ds_read_b64_tr_b16 v[110:111], v11 offset:37376
  ds_read_b64_tr_b16 v[112:113], v11 offset:45056
  ds_read_b64_tr_b16 v[114:115], v11 offset:45568
  s_waitcnt vmcnt(3)
  s_barrier
  s_waitcnt lgkmcnt(8)
  v_mfma_f32_16x16x32_bf16 v[16:19], v[144:147], v[136:139], v[16:19]
  s_add_u32 s67, s90, 2
  s_and_b32 s67, s67, 7
  s_lshl_b32 s67, s67, 7
  v_xor_b32_e64 v14, s67, v13
  s_cmp_ge_u32 s46, 4
  s_cbranch_scc1 L_ho_9
  s_add_u32 s57, s90, 4
  s_and_b32 s57, s57, 7
  s_mul_i32 s57, s57, 196608
  s_add_u32 m0, s56, 0
  s_nop 0
  buffer_load_dwordx4 v9, s[8:11], s57 offen lds
  s_add_u32 s57, s57, 1024
  s_add_u32 m0, s56, 8192
  s_nop 0
  buffer_load_dwordx4 v9, s[8:11], s57 offen lds
  s_add_u32 s57, s57, 1024
  s_add_u32 m0, s56, 16384
  s_nop 0
  buffer_load_dwordx4 v9, s[8:11], s57 offen lds
L_ho_9:
  v_mfma_f32_16x16x32_bf16 v[20:23], v[144:147], v[140:143], v[20:23]
  ds_read_b128 v[116:119], v14 offset:0
  ds_read_b64_tr_b16 v[124:125], v12 offset:0
  v_mfma_f32_16x16x32_bf16 v[24:27], v[148:151], v[136:139], v[24:27]
  ds_read_b64_tr_b16 v[126:127], v12 offset:512
  v_mfma_f32_16x16x32_bf16 v[28:31], v[148:151], v[140:143], v[28:31]
  ds_read_b128 v[120:123], v14 offset:16384
  ds_read_b64_tr_b16 v[128:129], v12 offset:8192
  v_mfma_f32_16x16x32_bf16 v[32:35], v[136:139], v[152:155], v[32:35]
  ds_read_b64_tr_b16 v[130:131], v12 offset:8704
  ds_read_b64_tr_b16 v[132:133], v12 offset:16384
  v_mfma_f32_16x16x32_bf16 v[36:39], v[140:143], v[152:155], v[36:39]
  ds_read_b64_tr_b16 v[134:135], v12 offset:16896
  s_waitcnt lgkmcnt(8)
  v_mfma_f32_16x16x32_bf16 v[16:19], v[104:107], v[96:99], v[16:19]
  v_xor_b32 v15, 64, v14
  s_cmp_lt_u32 s46, 4
  s_cbranch_scc1 L_ho_10
  s_add_u32 s57, s90, 4
  s_and_b32 s57, s57, 7
  s_mul_i32 s57, s57, 196608
  s_add_u32 m0, s56, 0
  s_nop 0
  buffer_load_dwordx4 v9, s[8:11], s57 offen lds
  s_add_u32 s57, s57, 1024
  s_add_u32 m0, s56, 8192
  s_nop 0
  buffer_load_dwordx4 v9, s[8:11], s57 offen lds
  s_add_u32 s57, s57, 1024
  s_add_u32 m0, s56, 16384
  s_nop 0
  buffer_load_dwordx4 v9, s[8:11], s57 offen lds
L_ho_10:
  v_mfma_f32_16x16x32_bf16 v[20:23], v[104:107], v[100:103], v[20:23]
  ds_read_b128 v[136:139], v15 offset:0
  ds_read_b64_tr_b16 v[144:145], v12 offset:4096
  v_mfma_f32_16x16x32_bf16 v[24:27], v[108:111], v[96:99], v[24:27]
  ds_read_b64_tr_b16 v[146:147], v12 offset:4608
  v_mfma_f32_16x16x32_bf16 v[28:31], v[108:111], v[100:103], v[28:31]
  ds_read_b128 v[140:143], v15 offset:16384
  ds_read_b64_tr_b16 v[148:149], v12 offset:12288
  v_mfma_f32_16x16x32_bf16 v[32:35], v[96:99], v[112:115], v[32:35]
  ds_read_b64_tr_b16 v[150:151], v12 offset:12800
  ds_read_b64_tr_b16 v[152:153], v12 offset:20480
  v_mfma_f32_16x16x32_bf16 v[36:39], v[100:103], v[112:115], v[36:39]
  ds_read_b64_tr_b16 v[154:155], v12 offset:20992
  s_waitcnt vmcnt(3)
  s_barrier
  s_waitcnt lgkmcnt(8)
  v_mfma_f32_16x16x32_bf16 v[16:19], v[124:127], v[116:119], v[16:19]
  s_add_u32 s67, s90, 3
  s_and_b32 s67, s67, 7
  s_lshl_b32 s67, s67, 7
  v_xor_b32_e64 v14, s67, v13
  s_cmp_ge_u32 s46, 4
  s_cbranch_scc1 L_ho_11
  s_add_u32 s57, s90, 5
  s_and_b32 s57, s57, 7
  s_mul_i32 s57, s57, 196608
  s_add_u32 m0, s56, 24576
  s_nop 0
  buffer_load_dwordx4 v9, s[8:11], s57 offen lds
  s_add_u32 s57, s57, 1024
  s_add_u32 m0, s56, 32768
  s_nop 0
  buffer_load_dwordx4 v9, s[8:11], s57 offen lds
  s_add_u32 s57, s57, 1024
  s_add_u32 m0, s56, 40960
  s_nop 0
  buffer_load_dwordx4 v9, s[8:11], s57 offen lds
L_ho_11:
  v_mfma_f32_16x16x32_bf16 v[20:23], v[124:127], v[120:123], v[20:23]
  ds_read_b128 v[96:99], v14 offset:0
  ds_read_b64_tr_b16 v[104:105], v12 offset:24576
  v_mfma_f32_16x16x32_bf16 v[24:27], v[128:131], v[116:119], v[24:27]
  ds_read_b64_tr_b16 v[106:107], v12 offset:25088
  v_mfma_f32_16x16x32_bf16 v[28:31], v[128:131], v[120:123], v[28:31]
  ds_read_b128 v[100:103], v14 offset:16384
  ds_read_b64_tr_b16 v[108:109], v12 offset:32768
  v_mfma_f32_16x16x32_bf16 v[32:35], v[116:119], v[132:135], v[32:35]
  ds_read_b64_tr_b16 v[110:111], v12 offset:33280
  ds_read_b64_tr_b16 v[112:113], v12 offset:40960
  v_mfma_f32_16x16x32_bf16 v[36:39], v[120:123], v[132:135], v[36:39]
  ds_read_b64_tr_b16 v[114:115], v12 offset:41472
  s_waitcnt lgkmcnt(8)
  v_mfma_f32_16x16x32_bf16 v[16:19], v[144:147], v[136:139], v[16:19]
  v_xor_b32_e64 v15, 64, v14
  s_cmp_lt_u32 s46, 4
  s_cbranch_scc1 L_ho_12
  s_add_u32 s57, s90, 5
  s_and_b32 s57, s57, 7
  s_mul_i32 s57, s57, 196608
  s_add_u32 m0, s56, 24576
  s_nop 0
  buffer_load_dwordx4 v9, s[8:11], s57 offen lds
  s_add_u32 s57, s57, 1024
  s_add_u32 m0, s56, 32768
  s_nop 0
  buffer_load_dwordx4 v9, s[8:11], s57 offen lds
  s_add_u32 s57, s57, 1024
  s_add_u32 m0, s56, 40960
  s_nop 0
  buffer_load_dwordx4 v9, s[8:11], s57 offen lds
L_ho_12:
  v_mfma_f32_16x16x32_bf16 v[20:23], v[144:147], v[140:143], v[20:23]
  ds_read_b128 v[116:119], v15 offset:0
  ds_read_b64_tr_b16 v[124:125], v12 offset:28672
  v_mfma_f32_16x16x32_bf16 v[24:27], v[148:151], v[136:139], v[24:27]
  ds_read_b64_tr_b16 v[126:127], v12 offset:29184
  v_mfma_f32_16x16x32_bf16 v[28:31], v[148:151], v[140:143], v[28:31]
  ds_read_b128 v[120:123], v15 offset:16384
  ds_read_b64_tr_b16 v[128:129], v12 offset:36864
  v_mfma_f32_16x16x32_bf16 v[32:35], v[136:139], v[152:155], v[32:35]
  ds_read_b64_tr_b16 v[130:131], v12 offset:37376
  ds_read_b64_tr_b16 v[132:133], v12 offset:45056
  v_mfma_f32_16x16x32_bf16 v[36:39], v[140:143], v[152:155], v[36:39]
  ds_read_b64_tr_b16 v[134:135], v12 offset:45568
  s_waitcnt vmcnt(3)
  s_barrier
  s_waitcnt lgkmcnt(8)
  v_mfma_f32_16x16x32_bf16 v[16:19], v[104:107], v[96:99], v[16:19]
  s_add_u32 s67, s90, 4
  s_and_b32 s67, s67, 7
  s_lshl_b32 s67, s67, 7
  v_xor_b32 v14, s67, v13
  s_cmp_ge_u32 s46, 4
  s_cbranch_scc1 L_ho_13
  s_add_u32 s57, s90, 6
  s_and_b32 s57, s57, 7
  s_mul_i32 s57, s57, 196608
  s_add_u32 m0, s56, 49152
  s_nop 0
  buffer_load_dwordx4 v9, s[8:11], s57 offen lds
  s_add_u32 s57, s57, 1024
  s_add_u32 m0, s56, 57344
  s_nop 0
  buffer_load_dwordx4 v9, s[8:11], s57 offen lds
  s_add_u32 s57, s57, 1024
  s_add_u32 m0, s56, 65536
  s_nop 0
  buffer_load_dwordx4 v9, s[8:11], s57 offen lds
L_ho_13:
  v_mfma_f32_16x16x32_bf16 v[20:23], v[104:107], v[100:103], v[20:23]
  ds_read_b128 v[136:139], v14 offset:0
  ds_read_b64_tr_b16 v[144:145], v11 offset:0
  v_mfma_f32_16x16x32_bf16 v[24:27], v[108:111], v[96:99], v[24:27]
  ds_read_b64_tr_b16 v[146:147], v11 offset:512
  v_mfma_f32_16x16x32_bf16 v[28:31], v[108:111], v[100:103], v[28:31]
  ds_read_b128 v[140:143], v14 offset:16384
  ds_read_b64_tr_b16 v[148:149], v11 offset:8192
  v_mfma_f32_16x16x32_bf16 v[32:35], v[96:99], v[112:115], v[32:35]
  ds_read_b64_tr_b16 v[150:151], v11 offset:8704
  ds_read_b64_tr_b16 v[152:153], v11 offset:16384
  v_mfma_f32_16x16x32_bf16 v[36:39], v[100:103], v[112:115], v[36:39]
  ds_read_b64_tr_b16 v[154:155], v11 offset:16896
  s_waitcnt lgkmcnt(8)
  v_mfma_f32_16x16x32_bf16 v[16:19], v[124:127], v[116:119], v[16:19]
  v_xor_b32_e64 v15, 64, v14
  s_cmp_lt_u32 s46, 4
  s_cbranch_scc1 L_ho_14
  s_add_u32 s57, s90, 6
  s_and_b32 s57, s57, 7
  s_mul_i32 s57, s57, 196608
  s_add_u32 m0, s56, 49152
  s_nop 0
  buffer_load_dwordx4 v9, s[8:11], s57 offen lds
  s_add_u32 s57, s57, 1024
  s_add_u32 m0, s56, 57344
  s_nop 0
  buffer_load_dwordx4 v9, s[8:11], s57 offen lds
  s_add_u32 s57, s57, 1024
  s_add_u32 m0, s56, 65536
  s_nop 0
  buffer_load_dwordx4 v9, s[8:11], s57 offen lds
L_ho_14:
  v_mfma_f32_16x16x32_bf16 v[20:23], v[124:127], v[120:123], v[20:23]
  ds_read_b128 v[96:99], v15 offset:0
  ds_read_b64_tr_b16 v[104:105], v11 offset:4096
  v_mfma_f32_16x16x32_bf16 v[24:27], v[128:131], v[116:119], v[24:27]
  ds_read_b64_tr_b16 v[106:107], v11 offset:4608
  v_mfma_f32_16x16x32_bf16 v[28:31], v[128:131], v[120:123], v[28:31]
  ds_read_b128 v[100:103], v15 offset:16384
  ds_read_b64_tr_b16 v[108:109], v11 offset:12288
  v_mfma_f32_16x16x32_bf16 v[32:35], v[116:119], v[132:135], v[32:35]
  ds_read_b64_tr_b16 v[110:111], v11 offset:12800
  ds_read_b64_tr_b16 v[112:113], v11 offset:20480
  v_mfma_f32_16x16x32_bf16 v[36:39], v[120:123], v[132:135], v[36:39]
  ds_read_b64_tr_b16 v[114:115], v11 offset:20992
  s_waitcnt vmcnt(3)
  s_barrier
  s_waitcnt lgkmcnt(8)
  v_mfma_f32_16x16x32_bf16 v[16:19], v[144:147], v[136:139], v[16:19]
  s_add_u32 s67, s90, 5
  s_and_b32 s67, s67, 7
  s_lshl_b32 s67, s67, 7
  v_xor_b32 v14, s67, v13
  s_cmp_ge_u32 s46, 4
  s_cbranch_scc1 L_ho_15
  s_add_u32 s57, s90, 7
  s_and_b32 s57, s57, 7
  s_mul_i32 s57, s57, 196608
  s_add_u32 m0, s56, 73728
  s_nop 0
  buffer_load_dwordx4 v9, s[8:11], s57 offen lds
  s_add_u32 s57, s57, 1024
  s_add_u32 m0, s56, 81920
  s_nop 0
  buffer_load_dwordx4 v9, s[8:11], s57 offen lds
  s_add_u32 s57, s57, 1024
  s_add_u32 m0, s56, 90112
  s_nop 0
  buffer_load_dwordx4 v9, s[8:11], s57 offen lds
L_ho_15:
  v_mfma_f32_16x16x32_bf16 v[20:23], v[144:147], v[140:143], v[20:23]
  ds_read_b128 v[116:119], v14 offset:0
  ds_read_b64_tr_b16 v[124:125], v11 offset:24576
  v_mfma_f32_16x16x32_bf16 v[24:27], v[148:151], v[136:139], v[24:27]
  ds_read_b64_tr_b16 v[126:127], v11 offset:25088
  v_mfma_f32_16x16x32_bf16 v[28:31], v[148:151], v[140:143], v[28:31]
  ds_read_b128 v[120:123], v14 offset:16384
  ds_read_b64_tr_b16 v[128:129], v11 offset:32768
  v_mfma_f32_16x16x32_bf16 v[32:35], v[136:139], v[152:155], v[32:35]
  ds_read_b64_tr_b16 v[130:131], v11 offset:33280
  ds_read_b64_tr_b16 v[132:133], v11 offset:40960
  v_mfma_f32_16x16x32_bf16 v[36:39], v[140:143], v[152:155], v[36:39]
  ds_read_b64_tr_b16 v[134:135], v11 offset:41472
  s_waitcnt lgkmcnt(8)
  v_mfma_f32_16x16x32_bf16 v[16:19], v[104:107], v[96:99], v[16:19]
  v_xor_b32_e64 v15, 64, v14
  s_cmp_lt_u32 s46, 4
  s_cbranch_scc1 L_ho_16
  s_add_u32 s57, s90, 7
  s_and_b32 s57, s57, 7
  s_mul_i32 s57, s57, 196608
  s_add_u32 m0, s56, 73728
  s_nop 0
  buffer_load_dwordx4 v9, s[8:11], s57 offen lds
  s_add_u32 s57, s57, 1024
  s_add_u32 m0, s56, 81920
  s_nop 0
  buffer_load_dwordx4 v9, s[8:11], s57 offen lds
  s_add_u32 s57, s57, 1024
  s_add_u32 m0, s56, 90112
  s_nop 0
  buffer_load_dwordx4 v9, s[8:11], s57 offen lds
L_ho_16:
  v_mfma_f32_16x16x32_bf16 v[20:23], v[104:107], v[100:103], v[20:23]
  ds_read_b128 v[136:139], v15 offset:0
  ds_read_b64_tr_b16 v[144:145], v11 offset:28672
  v_mfma_f32_16x16x32_bf16 v[24:27], v[108:111], v[96:99], v[24:27]
  ds_read_b64_tr_b16 v[146:147], v11 offset:29184
  ds_read_b128 v[140:143], v15 offset:16384
  v_mfma_f32_16x16x32_bf16 v[28:31], v[108:111], v[100:103], v[28:31]
  ds_read_b64_tr_b16 v[148:149], v11 offset:36864
  ds_read_b64_tr_b16 v[150:151], v11 offset:37376
  v_mfma_f32_16x16x32_bf16 v[32:35], v[96:99], v[112:115], v[32:35]
  ds_read_b64_tr_b16 v[152:153], v11 offset:45056
  ds_read_b64_tr_b16 v[154:155], v11 offset:45568
  v_mfma_f32_16x16x32_bf16 v[36:39], v[100:103], v[112:115], v[36:39]
  s_cmp_lg_u32 s46, 0
  s_cbranch_scc1 L_w0_17
  s_mov_b32 s3, 131072
L_nlp_18:
  v_cmp_eq_u32 vcc, 0, v3
  s_cbranch_vccz L_nok_19
  buffer_load_dword v3, v46, s[36:39], 0 offen sc1
  s_waitcnt vmcnt(0)
  s_sub_u32 s3, s3, 1
  s_cmp_lg_u32 s3, 0
  s_cbranch_scc1 L_nlp_18
L_nok_19:
  v_readfirstlane_b32 s100, v3
  v_add_u32 v40, s51, v3
L_w0_17:
  s_mov_b64 exec, 1
  buffer_store_dword v40, v8, s[40:43], 0 offen sc1
  s_mov_b64 exec, -1
  s_waitcnt vmcnt(4)
  s_barrier
  s_waitcnt lgkmcnt(8)
  v_mfma_f32_16x16x32_bf16 v[16:19], v[124:127], v[116:119], v[16:19]
  s_add_u32 s67, s90, 6
  s_and_b32 s67, s67, 7
  s_lshl_b32 s67, s67, 7
  v_xor_b32 v14, s67, v13
  ds_read_b128 v[96:99], v14 offset:0
  v_mfma_f32_16x16x32_bf16 v[20:23], v[124:127], v[120:123], v[20:23]
  ds_read_b64_tr_b16 v[104:105], v12 offset:0
  v_mfma_f32_16x16x32_bf16 v[24:27], v[128:131], v[116:119], v[24:27]
  ds_read_b64_tr_b16 v[106:107], v12 offset:512
  ds_read_b128 v[100:103], v14 offset:16384
  v_mfma_f32_16x16x32_bf16 v[28:31], v[128:131], v[120:123], v[28:31]
  ds_read_b64_tr_b16 v[108:109], v12 offset:8192
  v_mfma_f32_16x16x32_bf16 v[32:35], v[116:119], v[132:135], v[32:35]
  ds_read_b64_tr_b16 v[110:111], v12 offset:8704
  ds_read_b64_tr_b16 v[112:113], v12 offset:16384
  v_mfma_f32_16x16x32_bf16 v[36:39], v[120:123], v[132:135], v[36:39]
  ds_read_b64_tr_b16 v[114:115], v12 offset:16896
  s_waitcnt lgkmcnt(8)
  v_mfma_f32_16x16x32_bf16 v[16:19], v[144:147], v[136:139], v[16:19]
  v_xor_b32 v15, 64, v14
  ds_read_b128 v[116:119], v15 offset:0
  v_mfma_f32_16x16x32_bf16 v[20:23], v[144:147], v[140:143], v[20:23]
  ds_read_b64_tr_b16 v[124:125], v12 offset:4096
  v_mfma_f32_16x16x32_bf16 v[24:27], v[148:151], v[136:139], v[24:27]
  ds_read_b64_tr_b16 v[126:127], v12 offset:4608
  ds_read_b128 v[120:123], v15 offset:16384
  v_mfma_f32_16x16x32_bf16 v[28:31], v[148:151], v[140:143], v[28:31]
  ds_read_b64_tr_b16 v[128:129], v12 offset:12288
  v_mfma_f32_16x16x32_bf16 v[32:35], v[136:139], v[152:155], v[32:35]
  ds_read_b64_tr_b16 v[130:131], v12 offset:12800
  ds_read_b64_tr_b16 v[132:133], v12 offset:20480
  v_mfma_f32_16x16x32_bf16 v[36:39], v[140:143], v[152:155], v[36:39]
  ds_read_b64_tr_b16 v[134:135], v12 offset:20992
  s_waitcnt vmcnt(1)
  s_barrier
  s_waitcnt lgkmcnt(8)
  v_mfma_f32_16x16x32_bf16 v[16:19], v[104:107], v[96:99], v[16:19]
  s_add_u32 s67, s90, 7
  s_and_b32 s67, s67, 7
  s_lshl_b32 s67, s67, 7
  v_xor_b32_e64 v14, s67, v13
  ds_read_b128 v[136:139], v14 offset:0
  v_mfma_f32_16x16x32_bf16 v[20:23], v[104:107], v[100:103], v[20:23]
  ds_read_b64_tr_b16 v[144:145], v12 offset:24576
  v_mfma_f32_16x16x32_bf16 v[24:27], v[108:111], v[96:99], v[24:27]
  ds_read_b64_tr_b16 v[146:147], v12 offset:25088
  ds_read_b128 v[140:143], v14 offset:16384
  v_mfma_f32_16x16x32_bf16 v[28:31], v[108:111], v[100:103], v[28:31]
  ds_read_b64_tr_b16 v[148:149], v12 offset:32768
  v_mfma_f32_16x16x32_bf16 v[32:35], v[96:99], v[112:115], v[32:35]
  ds_read_b64_tr_b16 v[150:151], v12 offset:33280
  ds_read_b64_tr_b16 v[152:153], v12 offset:40960
  v_mfma_f32_16x16x32_bf16 v[36:39], v[100:103], v[112:115], v[36:39]
  ds_read_b64_tr_b16 v[154:155], v12 offset:41472
  s_waitcnt lgkmcnt(8)
  v_mfma_f32_16x16x32_bf16 v[16:19], v[124:127], v[116:119], v[16:19]
  v_xor_b32 v15, 64, v14
  ds_read_b128 v[96:99], v15 offset:0
  v_mfma_f32_16x16x32_bf16 v[20:23], v[124:127], v[120:123], v[20:23]
  ds_read_b64_tr_b16 v[104:105], v12 offset:28672
  v_mfma_f32_16x16x32_bf16 v[24:27], v[128:131], v[116:119], v[24:27]
  ds_read_b64_tr_b16 v[106:107], v12 offset:29184
  ds_read_b128 v[100:103], v15 offset:16384
  v_mfma_f32_16x16x32_bf16 v[28:31], v[128:131], v[120:123], v[28:31]
  ds_read_b64_tr_b16 v[108:109], v12 offset:36864
  v_mfma_f32_16x16x32_bf16 v[32:35], v[116:119], v[132:135], v[32:35]
  ds_read_b64_tr_b16 v[110:111], v12 offset:37376
  ds_read_b64_tr_b16 v[112:113], v12 offset:45056
  v_mfma_f32_16x16x32_bf16 v[36:39], v[120:123], v[132:135], v[36:39]
  ds_read_b64_tr_b16 v[114:115], v12 offset:45568
  s_waitcnt lgkmcnt(8)
  v_mfma_f32_16x16x32_bf16 v[16:19], v[144:147], v[136:139], v[16:19]
  v_mfma_f32_16x16x32_bf16 v[20:23], v[144:147], v[140:143], v[20:23]
  v_mfma_f32_16x16x32_bf16 v[24:27], v[148:151], v[136:139], v[24:27]
  v_mfma_f32_16x16x32_bf16 v[28:31], v[148:151], v[140:143], v[28:31]
  v_mfma_f32_16x16x32_bf16 v[32:35], v[136:139], v[152:155], v[32:35]
  v_mfma_f32_16x16x32_bf16 v[36:39], v[140:143], v[152:155], v[36:39]
  s_waitcnt lgkmcnt(0)
  v_mfma_f32_16x16x32_bf16 v[16:19], v[104:107], v[96:99], v[16:19]
  v_mfma_f32_16x16x32_bf16 v[20:23], v[104:107], v[100:103], v[20:23]
  v_mfma_f32_16x16x32_bf16 v[24:27], v[108:111], v[96:99], v[24:27]
  v_mfma_f32_16x16x32_bf16 v[28:31], v[108:111], v[100:103], v[28:31]
  v_mfma_f32_16x16x32_bf16 v[32:35], v[96:99], v[112:115], v[32:35]
  v_mfma_f32_16x16x32_bf16 v[36:39], v[100:103], v[112:115], v[36:39]
  s_mov_b32 s66, 0x3eb8aa3b
  s_add_u32 s70, s65, 262144
  s_add_u32 s68, s65, 524288
  v_lshrrev_b32 v5, 4, v1
  v_and_b32 v6, 1, v5
  v_lshrrev_b32 v5, 1, v5
  v_lshlrev_b32 v6, 9, v6
  v_lshl_add_u32 v6, v5, 8, v6
  v_and_b32_e64 v5, 15, v1
  v_lshl_add_u32 v6, v5, 4, v6
  v_lshlrev_b32 v7, 2, v1
  v_mul_f32 v16, s66, v16
  v_mul_f32 v17, s66, v17
  v_mul_f32 v18, s66, v18
  v_mul_f32 v19, s66, v19
  v_mul_f32 v20, s66, v20
  v_mul_f32 v21, s66, v21
  v_mul_f32 v22, s66, v22
  v_mul_f32_e64 v23, s66, v23
  v_cvt_pk_bf16_f32 v68, v24, v25
  v_cvt_pk_bf16_f32 v69, v26, v27
  v_cvt_pk_bf16_f32 v70, v28, v29
  v_cvt_pk_bf16_f32 v71, v30, v31
  v_cvt_pk_bf16_f32 v72, v32, v33
  v_cvt_pk_bf16_f32 v73, v34, v35
  v_cvt_pk_bf16_f32 v74, v36, v37
  v_cvt_pk_bf16_f32 v75, v38, v39
  v_cvt_pk_bf16_f32 v64, v16, v17
  v_cvt_pk_bf16_f32 v65, v18, v19
  v_cvt_pk_bf16_f32 v66, v20, v21
  v_cvt_pk_bf16_f32 v67, v22, v23
  v_mov_b32_e64 v40, 0
  v_permlane16_swap_b32 v68, v70
  v_permlane16_swap_b32 v69, v71
  v_permlane16_swap_b32 v72, v74
  v_permlane16_swap_b32 v73, v75
  v_permlane16_swap_b32 v64, v66
  v_permlane16_swap_b32 v65, v67
  buffer_store_dwordx4 v[68:71], v4, s[40:43], s70 offen sc1
  buffer_store_dwordx4 v[72:75], v6, s[40:43], s68 offen sc1
  buffer_store_dwordx4 v[64:67], v4, s[40:43], s65 offen sc1
  v_dot2c_f32_bf16 v40, v64, v68
  v_dot2c_f32_bf16 v40, v65, v69
  v_dot2c_f32_bf16 v40, v66, v70
  v_dot2c_f32_bf16 v40, v67, v71
  s_nop 2
  v_cvt_pk_bf16_f32 v40, v40, 0
  buffer_store_dword v40, v7, s[40:43], s69 offen sc1
  s_cmp_lg_u32 s46, 0
  s_cbranch_scc1 L_w0_20
  s_lshl_b32 s96, s44, 7
  s_mov_b32 exec_lo, 0xffffffff
  s_mov_b32 exec_hi, 0x0
  buffer_load_dword v41, v7, s[40:43], s96 offen sc1
  s_mov_b64 exec, -1
L_w0_20:
  s_waitcnt vmcnt(0)
  s_waitcnt lgkmcnt(0)
  s_barrier
  s_cmp_lg_u32 s46, 0
  s_cbranch_scc1 L_w0_21
  s_mov_b64 exec, 0x1
  buffer_store_dword v3, v2, s[40:43], 0 offen sc1
  s_mov_b64 exec, -1
L_w0_21:
  s_cmp_lg_u32 s46, 0
  s_cbranch_scc1 L_w0_22
  s_add_u32 s97, s100, s51
  s_mov_b32 s3, 131072
  s_mov_b32 exec_lo, 0xffffffff
  s_mov_b32 exec_hi, 0x0
L_mlp_23:
  v_cmp_ne_u32 vcc, s97, v41
  s_cbranch_vccz L_mfast_24
  v_subrev_u32 v40, s100, v41
  v_cmp_le_u32 vcc, 16, v40
  s_cbranch_vccz L_mout_25
  buffer_load_dword v41, v7, s[40:43], s96 offen sc1
  s_waitcnt vmcnt(0)
  s_sub_u32 s3, s3, 1
  s_cmp_lg_u32 s3, 0
  s_cbranch_scc1 L_mlp_23
  s_branch L_mout_25
L_mfast_24:
  s_mov_b32 s47, 1
L_mout_25:
  s_mov_b64 exec, -1
L_w0_22:
  s_lshl_b32 s56, s44, 2
  s_lshr_b32 s64, s45, 3
  s_add_u32 s56, s56, s64
  s_lshl_b32 s58, s64, 6
  s_and_b32 s64, s45, 7
  s_lshl_b32 s64, s64, 1
  s_and_b32 s65, s46, 1
  s_add_u32 s64, s64, s65
  s_lshl_b32 s57, s64, 2
  s_add_u32 s57, s57, s58
  s_lshr_b32 s60, s46, 1
  s_lshl_b32 s65, s60, 4
  s_add_u32 s58, s58, s65
  s_lshl_b32 s58, s58, 10
  s_add_u32 s58, s58, s101
  s_add_u32 s59, s58, 524288
  s_add_u32 s58, s58, 262144
  v_lshrrev_b32 v5, 3, v1
  v_and_b32 v6, 7, v1
  v_and_b32 v231, 6, v5
  v_xor_b32 v231, v231, v6
  v_lshlrev_b32_e64 v231, 4, v231
  v_lshl_add_u32 v231, v5, 10, v231
  s_lshl_b32 s64, s46, 13
  s_lshl_b32 s65, s49, 7
  s_add_u32 s64, s64, s65
  v_add_u32 v231, s64, v231
  v_lshrrev_b32 v5, 3, v1
  v_and_b32 v6, 7, v1
  v_and_b32 v7, 6, v5
  v_xor_b32 v6, v6, v7
  s_lshl_b32 s64, s46, 3
  v_add_u32 v5, s64, v5
  v_mul_u32_u24 v5, 2752, v5
  s_lshl_b32 s64, s52, 5
  v_add_u32 v5, s64, v5
  v_lshl_add_u32 v244, v6, 4, v5
  s_and_b32 s64, s52, 1
  s_cmp_eq_u32 s64, 1
  s_cselect_b32 s65, 160, 32
  s_cselect_b32 s66, 0, 128
  s_cselect_b32 s67, 32, 160
  s_cselect_b32 s68, 128, 0
  s_add_u32 s68, s68, 1376
  s_lshl_b32 s92, s64, 5
  s_sub_u32 s93, 1408, s92
  v_bfe_u32 v7, v6, 1, 1
  v_and_b32 v245, 1, v6
  v_lshl_add_u32 v5, v245, 4, v5
  v_mul_u32_u24 v245, s65, v7
  v_add_u32 v245, s66, v245
  v_mul_u32_u24 v7, s67, v7
  v_add_u32 v7, s68, v7
  v_cmp_gt_u32 vcc, 4, v6
  s_nop 1
  v_cndmask_b32 v245, v245, v7, vcc
  v_add_u32 v245, v245, v5
  s_cmp_eq_u32 s53, 1
  s_cselect_b32 s64, 0, 0x40000000
  v_bfe_u32 v7, v6, 1, 1
  v_mul_lo_u32 v7, v7, s64
  v_add_u32_e64 v245, v245, v7
  s_lshl_b32 s64, s45, 3
  s_add_u32 s64, s64, s46
  s_lshl_b32 s65, s44, 8
  s_add_u32 s65, s65, s64
  s_mul_i32 s66, s64, 5504
  v_min_u32 v234, 42, v1
  v_lshlrev_b32 v234, 7, v234
  v_add_u32_e64 v234, s66, v234
  s_mul_i32 s66, s64, 4096
  s_lshl_b32 s67, s44, 20
  s_add_u32 s66, s66, s67
  v_min_u32 v235, 31, v1
  v_lshlrev_b32 v235, 7, v235
  v_add_u32_e64 v235, s66, v235
  s_mul_i32 s66, s65, 384
  v_min_u32 v236, 2, v1
  v_lshlrev_b32 v236, 7, v236
  v_add_u32_e64 v236, s66, v236
  v_mov_b32 v228, 0xdddddddd
  v_and_b32 v5, 15, v1
  v_lshrrev_b32 v6, 5, v1
  v_lshlrev_b32_e64 v229, 4, v5
  v_lshl_add_u32 v229, v6, 8, v229
  v_and_b32_e64 v5, 31, v1
  v_mov_b32 v6, 0x3f803f80
  v_cmp_eq_u32 vcc, 16, v5
  s_nop 1
  v_cndmask_b32 v230, 0, v6, vcc
  v_mov_b32 v204, v230
  v_mov_b32 v205, v230
  v_mov_b32 v206, v230
  v_mov_b32 v207, v230
  v_mov_b32 v208, v230
  v_mov_b32 v209, v230
  v_mov_b32 v210, v230
  v_mov_b32 v211, v230
  v_mov_b32 v212, v230
  v_mov_b32 v213, v230
  v_mov_b32 v214, v230
  v_mov_b32 v215, v230
  v_mov_b32 v216, v230
  v_mov_b32 v217, v230
  v_mov_b32 v218, v230
  v_mov_b32 v219, v230
  v_mov_b32 v220, v230
  v_mov_b32 v221, v230
  v_mov_b32 v222, v230
  v_mov_b32 v223, v230
  v_mov_b32 v224, v230
  v_mov_b32 v225, v230
  v_mov_b32 v226, v230
  v_mov_b32 v227, v230
  v_mov_b32 v184, 0
  v_mov_b32 v185, 0
  v_mov_b32 v186, 0
  v_mov_b32_e64 v187, 0
  v_mov_b32 v240, 0xbf80
  v_mov_b32 v241, 0
  v_mov_b32 v242, 0
  v_mov_b32 v243, 0
  v_lshlrev_b32 v7, 2, v1
  v_mov_b32 v5, 90112
  ds_write_b32 v5, v184
  s_cmp_lg_u32 s46, 0
  s_cbranch_scc1 L_w0_26
  ds_write_b32 v5, v3 offset:16
L_w0_26:
  v_mfma_f32_32x32x16_bf16 v[96:111], v[184:187], v[184:187], 0
  v_mfma_f32_32x32x16_bf16 v[112:127], v[184:187], v[184:187], 0
  v_mfma_f32_32x32x16_bf16 v[128:143], v[184:187], v[184:187], 0
  v_mfma_f32_32x32x16_bf16 v[144:159], v[184:187], v[184:187], 0
  s_lshl_b32 s72, s48, 1
  s_add_u32 s72, s72, s44
  s_add_u32 s72, s72, 0
  s_and_b32 s72, s72, 7
  s_lshl_b32 s73, s72, 3
  s_add_u32 s73, s73, s46
  s_lshl_b32 s73, s73, 10
  s_add_u32 m0, s73, 98304
  s_add_u32 s72, s72, s49
  s_and_b32 s72, s72, 7
  s_lshl_b32 s72, s72, 16
  buffer_load_dwordx4 v231, s[12:15], s72 offen lds
  s_lshl_b32 s72, s48, 1
  s_add_u32 s72, s72, s44
  s_add_u32 s72, s72, 1
  s_and_b32 s72, s72, 7
  s_lshl_b32 s73, s72, 3
  s_add_u32 s73, s73, s46
  s_lshl_b32 s73, s73, 10
  s_add_u32 m0, s73, 98304
  s_add_u32 s72, s72, s49
  s_and_b32 s72, s72, 7
  s_lshl_b32 s72, s72, 16
  buffer_load_dwordx4 v231, s[12:15], s72 offen lds
  s_lshl_b32 s72, s48, 1
  s_add_u32 s72, s72, s44
  s_add_u32 s72, s72, 2
  s_and_b32 s72, s72, 7
  s_lshl_b32 s73, s72, 3
  s_add_u32 s73, s73, s46
  s_lshl_b32 s73, s73, 10
  s_add_u32 m0, s73, 98304
  s_add_u32 s72, s72, s49
  s_and_b32 s72, s72, 7
  s_lshl_b32 s72, s72, 16
  buffer_load_dwordx4 v231, s[12:15], s72 offen lds
  s_lshl_b32 s72, s48, 1
  s_add_u32 s72, s72, s44
  s_add_u32 s72, s72, 3
  s_and_b32 s72, s72, 7
  s_lshl_b32 s73, s72, 3
  s_add_u32 s73, s73, s46
  s_lshl_b32 s73, s73, 10
  s_add_u32 m0, s73, 98304
  s_add_u32 s72, s72, s49
  s_and_b32 s72, s72, 7
  s_lshl_b32 s72, s72, 16
  buffer_load_dwordx4 v231, s[12:15], s72 offen lds
  s_lshl_b32 s72, s48, 1
  s_add_u32 s72, s72, s44
  s_add_u32 s72, s72, 4
  s_and_b32 s72, s72, 7
  s_lshl_b32 s73, s72, 3
  s_add_u32 s73, s73, s46
  s_lshl_b32 s73, s73, 10
  s_add_u32 m0, s73, 98304
  s_add_u32 s72, s72, s49
  s_and_b32 s72, s72, 7
  s_lshl_b32 s72, s72, 16
  buffer_load_dwordx4 v231, s[12:15], s72 offen lds
  s_lshl_b32 s72, s48, 1
  s_add_u32 s72, s72, s44
  s_add_u32 s72, s72, 5
  s_and_b32 s72, s72, 7
  s_lshl_b32 s73, s72, 3
  s_add_u32 s73, s73, s46
  s_lshl_b32 s73, s73, 10
  s_add_u32 m0, s73, 98304
  s_add_u32 s72, s72, s49
  s_and_b32 s72, s72, 7
  s_lshl_b32 s72, s72, 16
  buffer_load_dwordx4 v231, s[12:15], s72 offen lds
  s_lshl_b32 s72, s48, 1
  s_add_u32 s72, s72, s44
  s_add_u32 s72, s72, 6
  s_and_b32 s72, s72, 7
  s_lshl_b32 s73, s72, 3
  s_add_u32 s73, s73, s46
  s_lshl_b32 s73, s73, 10
  s_add_u32 m0, s73, 98304
  s_add_u32 s72, s72, s49
  s_and_b32 s72, s72, 7
  s_lshl_b32 s72, s72, 16
  buffer_load_dwordx4 v231, s[12:15], s72 offen lds
  s_lshl_b32 s72, s48, 1
  s_add_u32 s72, s72, s44
  s_add_u32 s72, s72, 7
  s_and_b32 s72, s72, 7
  s_lshl_b32 s73, s72, 3
  s_add_u32 s73, s73, s46
  s_lshl_b32 s73, s73, 10
  s_add_u32 m0, s73, 98304
  s_add_u32 s72, s72, s49
  s_and_b32 s72, s72, 7
  s_lshl_b32 s72, s72, 16
  buffer_load_dwordx4 v231, s[12:15], s72 offen lds
  s_waitcnt lgkmcnt(0)
  s_cmp_lg_u32 s46, 0
  s_cbranch_scc1 L_w0_27
  s_lshl_b32 s96, s44, 10
  s_add_u32 s96, s96, 4096
  v_lshlrev_b32_e64 v5, 5, v1
  s_mov_b32 exec_lo, 0xffffffff
  s_mov_b32 exec_hi, 0x0
  s_mov_b32 s3, 131072
L_poll_28:
  buffer_load_dword v6, v5, s[40:43], s96 offen sc1
  s_waitcnt vmcnt(0)
  v_cmp_ne_u32 vcc, v6, v3
  s_cbranch_vccz L_pok_29
  s_sub_u32 s3, s3, 1
  s_cmp_lg_u32 s3, 0
  s_cbranch_scc1 L_poll_28
L_pok_29:
  s_mov_b64 exec, -1
L_w0_27:
  s_barrier
  v_mov_b32 v5, 90112
  ds_read_b32 v3, v5 offset:16
  s_add_u32 s64, s60, 1
  s_and_b32 s64, s64, 3
  s_add_u32 s64, s64, s57
  s_lshl_b32 s65, s64, 8
  s_add_u32 s65, s65, s101
  s_add_u32 s65, s65, 786432
  s_lshl_b32 s64, s64, 10
  s_add_u32 s64, s64, s101
  buffer_load_dword v232, v7, s[40:43], s65 offen sc1
  buffer_load_dwordx4 v[16:19], v4, s[40:43], s64 offen sc1
  s_add_u32 s64, s59, 0
  s_add_u32 s65, s58, 0
  s_mov_b64 exec, s[98:99]
  buffer_load_dwordx4 v[204:207], v229, s[40:43], s64 offen sc1
  buffer_load_dwordx4 v[208:211], v229, s[40:43], s64 offen offset:512 sc1
  s_mov_b64 exec, -1
  buffer_load_dwordx4 v[192:195], v4, s[40:43], s65 offen sc1
  s_add_u32 s64, s60, 2
  s_and_b32 s64, s64, 3
  s_add_u32 s64, s64, s57
  s_lshl_b32 s65, s64, 8
  s_add_u32 s65, s65, s101
  s_add_u32 s65, s65, 786432
  s_lshl_b32 s64, s64, 10
  s_add_u32 s64, s64, s101
  buffer_load_dword v233, v7, s[40:43], s65 offen sc1
  buffer_load_dwordx4 v[20:23], v4, s[40:43], s64 offen sc1
  s_add_u32 s64, s60, 3
  s_and_b32 s64, s64, 3
  s_add_u32 s64, s64, s57
  s_lshl_b32 s65, s64, 8
  s_add_u32 s65, s65, s101
  s_add_u32 s65, s65, 786432
  s_lshl_b32 s64, s64, 10
  s_add_u32 s64, s64, s101
  buffer_load_dword v237, v7, s[40:43], s65 offen sc1
  buffer_load_dwordx4 v[24:27], v4, s[40:43], s64 offen sc1
  s_add_u32 s64, s60, 4
  s_and_b32 s64, s64, 3
  s_add_u32 s64, s64, s57
  s_lshl_b32 s65, s64, 8
  s_add_u32 s65, s65, s101
  s_add_u32 s65, s65, 786432
  s_lshl_b32 s64, s64, 10
  s_add_u32 s64, s64, s101
  buffer_load_dword v238, v7, s[40:43], s65 offen sc1
  buffer_load_dwordx4 v[28:31], v4, s[40:43], s64 offen sc1
  s_add_u32 s64, s59, 1024
  s_add_u32 s65, s58, 1024
  s_mov_b64 exec, s[98:99]
  buffer_load_dwordx4 v[212:215], v229, s[40:43], s64 offen sc1
  buffer_load_dwordx4 v[216:219], v229, s[40:43], s64 offen offset:512 sc1
  s_mov_b64 exec, -1
  buffer_load_dwordx4 v[196:199], v4, s[40:43], s65 offen sc1
  s_waitcnt lgkmcnt(0)
  v_lshlrev_b32_e64 v8, 2, v1
  s_add_u32 s64, s60, 1
  s_and_b32 s64, s64, 3
  s_lshl_b32 s64, s64, 1
  s_and_b32 s65, s46, 1
  s_add_u32 s64, s64, s65
  s_mul_i32 s64, s64, 6912
  s_add_u32 s64, s64, 0
  v_add_u32 v12, s64, v4
  v_add_u32 v5, s64, v8
  s_add_u32 s64, s60, 2
  s_and_b32 s64, s64, 3
  s_lshl_b32 s64, s64, 1
  s_and_b32 s65, s46, 1
  s_add_u32 s64, s64, s65
  s_mul_i32 s64, s64, 6912
  s_add_u32 s64, s64, 2304
  v_add_u32 v13, s64, v4
  v_add_u32_e64 v6, s64, v8
  s_add_u32 s64, s60, 3
  s_and_b32 s64, s64, 3
  s_lshl_b32 s64, s64, 1
  s_and_b32 s65, s46, 1
  s_add_u32 s64, s64, s65
  s_mul_i32 s64, s64, 6912
  s_add_u32 s64, s64, 4608
  v_add_u32 v14, s64, v4
  v_add_u32 v7, s64, v8
  s_mul_i32 s64, s46, 6912
  v_add_u32 v9, s64, v4
  v_and_b32 v10, 31, v1
  v_lshlrev_b32 v10, 2, v10
  v_add_u32 v10, s64, v10
  v_bfe_u32 v11, v1, 4, 1
  v_lshlrev_b32 v11, 14, v11
  v_add_u32_e64 v11, v11, v229
  s_and_b32 s64, s45, 7
  s_lshl_b32 s64, s64, 3
  s_and_b32 s65, s46, 1
  s_lshl_b32 s65, s65, 2
  s_add_u32 s64, s64, s65
  s_add_u32 s64, s64, s60
  s_lshl_b32 s64, s64, 15
  s_lshl_b32 s65, s56, 9
  s_add_u32 s64, s64, s65
  s_add_u32 s61, s64, 2097152
  s_waitcnt vmcnt(12)
  v_mov_b32_e64 v220, v232
  s_nop 1
  v_mfma_f32_32x32x16_bf16 v[32:47], v[240:243], v[220:223], 0
  s_waitcnt vmcnt(9)
  v_mfma_f32_32x32x16_bf16 v[160:175], v[192:195], v[16:19], v[32:47]
  s_setprio 3
  s_nop 10
  v_exp_f32 v160, v160
  v_exp_f32 v161, v161
  s_waitcnt vmcnt(7)
  v_mov_b32 v220, v233
  s_nop 1
  v_mfma_f32_32x32x16_bf16 v[48:63], v[240:243], v[220:223], 0
  v_exp_f32 v162, v162
  v_exp_f32 v163, v163
  v_exp_f32 v164, v164
  v_exp_f32 v165, v165
  v_exp_f32_e64 v166, v166
  v_mfma_f32_32x32x16_bf16 v[176:191], v[192:195], v[20:23], v[48:63]
  v_exp_f32 v167, v167
  v_exp_f32 v168, v168
  v_exp_f32 v169, v169
  v_exp_f32 v170, v170
  v_exp_f32_e64 v171, v171
  v_smfmac_f32_32x32x32_bf16 v[96:111], v[204:207], v[160:167], v228
  v_exp_f32 v172, v172
  v_exp_f32 v173, v173
  v_exp_f32 v174, v174
  v_exp_f32 v175, v175
  v_exp_f32 v176, v176
  v_exp_f32 v177, v177
  v_smfmac_f32_32x32x32_bf16 v[96:111], v[208:211], v[168:175], v228
  s_waitcnt vmcnt(5)
  v_mov_b32_e64 v220, v237
  s_nop 1
  v_mfma_f32_32x32x16_bf16 v[64:79], v[240:243], v[220:223], 0
  v_exp_f32 v178, v178
  v_exp_f32 v179, v179
  v_exp_f32 v180, v180
  v_exp_f32 v181, v181
  v_exp_f32_e64 v182, v182
  v_mfma_f32_32x32x16_bf16 v[160:175], v[192:195], v[24:27], v[64:79]
  v_exp_f32 v183, v183
  v_exp_f32 v184, v184
  v_exp_f32 v185, v185
  v_exp_f32 v186, v186
  v_exp_f32_e64 v187, v187
  v_smfmac_f32_32x32x32_bf16 v[112:127], v[204:207], v[176:183], v228
  v_exp_f32 v188, v188
  v_exp_f32 v189, v189
  v_exp_f32 v190, v190
  v_exp_f32 v191, v191
  v_exp_f32 v160, v160
  v_exp_f32 v161, v161
  v_smfmac_f32_32x32x32_bf16 v[112:127], v[208:211], v[184:191], v228
  s_waitcnt vmcnt(3)
  v_mov_b32_e64 v220, v238
  s_nop 1
  v_mfma_f32_32x32x16_bf16 v[80:95], v[240:243], v[220:223], 0
  v_exp_f32 v162, v162
  v_exp_f32 v163, v163
  v_exp_f32 v164, v164
  v_exp_f32 v165, v165
  v_exp_f32_e64 v166, v166
  v_mfma_f32_32x32x16_bf16 v[176:191], v[192:195], v[28:31], v[80:95]
  v_exp_f32 v167, v167
  v_exp_f32 v168, v168
  v_exp_f32 v169, v169
  v_exp_f32 v170, v170
  v_exp_f32_e64 v171, v171
  v_smfmac_f32_32x32x32_bf16 v[128:143], v[204:207], v[160:167], v228
  v_exp_f32 v172, v172
  v_exp_f32 v173, v173
  v_exp_f32 v174, v174
  v_exp_f32 v175, v175
L_att_step3:
  v_exp_f32 v176, v176
  v_exp_f32 v177, v177
  v_smfmac_f32_32x32x32_bf16 v[128:143], v[208:211], v[168:175], v228
  v_exp_f32 v178, v178
  v_mov_b32 v220, v230
  s_add_u32 s64, s59, 2048
  s_add_u32 s65, s58, 2048
  s_mov_b64 exec, s[98:99]
  buffer_load_dwordx4 v[220:223], v229, s[40:43], s64 offen sc1
  buffer_load_dwordx4 v[224:227], v229, s[40:43], s64 offen offset:512 sc1
  s_mov_b64 exec, -1
  buffer_load_dwordx4 v[200:203], v4, s[40:43], s65 offen sc1
  v_exp_f32 v179, v179
  v_exp_f32 v180, v180
  v_exp_f32 v181, v181
  s_waitcnt vmcnt(3)
  v_exp_f32_e64 v182, v182
  v_mfma_f32_32x32x16_bf16 v[160:175], v[196:199], v[16:19], v[32:47]
  v_exp_f32 v183, v183
  v_exp_f32 v184, v184
  v_exp_f32 v185, v185
  v_exp_f32 v186, v186
  v_exp_f32_e64 v187, v187
  v_smfmac_f32_32x32x32_bf16 v[144:159], v[204:207], v[176:183], v228
  v_exp_f32 v188, v188
  v_exp_f32 v189, v189
  v_exp_f32 v190, v190
  v_exp_f32 v191, v191
  v_exp_f32 v160, v160
  v_exp_f32 v161, v161
  v_smfmac_f32_32x32x32_bf16 v[144:159], v[208:211], v[184:191], v228
  v_exp_f32_e64 v162, v162
  s_add_u32 s64, s59, 3072
  s_add_u32 s65, s58, 3072
  s_mov_b64 exec, s[98:99]
  buffer_load_dwordx4 v[204:207], v229, s[40:43], s64 offen sc1
  buffer_load_dwordx4 v[208:211], v229, s[40:43], s64 offen offset:512 sc1
  s_mov_b64 exec, -1
  buffer_load_dwordx4 v[192:195], v4, s[40:43], s65 offen sc1
  v_exp_f32 v163, v163
  v_exp_f32 v164, v164
  v_exp_f32 v165, v165
  v_exp_f32 v166, v166
  v_mfma_f32_32x32x16_bf16 v[176:191], v[196:199], v[20:23], v[48:63]
  v_exp_f32 v167, v167
  v_exp_f32 v168, v168
  v_exp_f32 v169, v169
  v_exp_f32 v170, v170
  v_exp_f32_e64 v171, v171
  v_smfmac_f32_32x32x32_bf16 v[96:111], v[212:215], v[160:167], v228
  v_exp_f32 v172, v172
  v_exp_f32 v173, v173
  v_exp_f32 v174, v174
  v_exp_f32 v175, v175
  v_exp_f32 v176, v176
  v_exp_f32 v177, v177
  v_smfmac_f32_32x32x32_bf16 v[96:111], v[216:219], v[168:175], v228
  v_exp_f32_e64 v178, v178
  buffer_load_dword v247, v236, s[28:31], 0 offen
  v_exp_f32 v179, v179
  v_exp_f32 v180, v180
  v_exp_f32 v181, v181
  v_exp_f32 v182, v182
  v_mfma_f32_32x32x16_bf16 v[160:175], v[196:199], v[24:27], v[64:79]
  v_exp_f32 v183, v183
  v_exp_f32 v184, v184
  v_exp_f32 v185, v185
  v_exp_f32 v186, v186
  v_exp_f32_e64 v187, v187
  v_smfmac_f32_32x32x32_bf16 v[112:127], v[212:215], v[176:183], v228
  v_exp_f32 v188, v188
  v_exp_f32 v189, v189
  v_exp_f32 v190, v190
  v_exp_f32 v191, v191
  v_exp_f32 v160, v160
  v_exp_f32 v161, v161
  v_smfmac_f32_32x32x32_bf16 v[112:127], v[216:219], v[184:191], v228
  v_exp_f32 v162, v162
  v_exp_f32 v163, v163
  v_exp_f32 v164, v164
  v_exp_f32 v165, v165
  v_exp_f32_e64 v166, v166
  v_mfma_f32_32x32x16_bf16 v[176:191], v[196:199], v[28:31], v[80:95]
  v_exp_f32 v167, v167
  v_exp_f32 v168, v168
  v_exp_f32 v169, v169
  v_exp_f32 v170, v170
  v_exp_f32_e64 v171, v171
  v_smfmac_f32_32x32x32_bf16 v[128:143], v[212:215], v[160:167], v228
  v_exp_f32 v172, v172
  v_exp_f32 v173, v173
  v_exp_f32 v174, v174
  v_exp_f32 v175, v175
  v_exp_f32 v176, v176
  v_exp_f32 v177, v177
  v_smfmac_f32_32x32x32_bf16 v[128:143], v[216:219], v[168:175], v228
  v_exp_f32 v178, v178
  v_exp_f32 v179, v179
  v_exp_f32 v180, v180
  v_exp_f32 v181, v181
  s_waitcnt vmcnt(4)
  v_exp_f32 v182, v182
  v_mfma_f32_32x32x16_bf16 v[160:175], v[200:203], v[16:19], v[32:47]
  v_exp_f32 v183, v183
  v_exp_f32 v184, v184
  v_exp_f32 v185, v185
  v_exp_f32 v186, v186
  v_exp_f32_e64 v187, v187
  v_smfmac_f32_32x32x32_bf16 v[144:159], v[212:215], v[176:183], v228
  v_exp_f32 v188, v188
  v_exp_f32 v189, v189
  v_exp_f32 v190, v190
  v_exp_f32 v191, v191
  v_exp_f32 v160, v160
  v_exp_f32 v161, v161
  v_smfmac_f32_32x32x32_bf16 v[144:159], v[216:219], v[184:191], v228
  v_exp_f32_e64 v162, v162
  s_add_u32 s64, s59, 4096
  s_add_u32 s65, s58, 4096
  s_mov_b64 exec, s[98:99]
  buffer_load_dwordx4 v[212:215], v229, s[40:43], s64 offen sc1
  buffer_load_dwordx4 v[216:219], v229, s[40:43], s64 offen offset:512 sc1
  s_mov_b64 exec, -1
  buffer_load_dwordx4 v[196:199], v4, s[40:43], s65 offen sc1
  v_exp_f32 v163, v163
  v_exp_f32 v164, v164
  v_exp_f32 v165, v165
  v_exp_f32 v166, v166
  v_mfma_f32_32x32x16_bf16 v[176:191], v[200:203], v[20:23], v[48:63]
  v_exp_f32 v167, v167
  v_exp_f32 v168, v168
  v_exp_f32 v169, v169
  v_exp_f32 v170, v170
  v_exp_f32_e64 v171, v171
  v_smfmac_f32_32x32x32_bf16 v[96:111], v[220:223], v[160:167], v228
  v_exp_f32 v172, v172
  v_exp_f32 v173, v173
  v_exp_f32 v174, v174
  v_exp_f32 v175, v175
  v_exp_f32 v176, v176
  v_exp_f32 v177, v177
  v_smfmac_f32_32x32x32_bf16 v[96:111], v[224:227], v[168:175], v228
  v_exp_f32 v178, v178
  v_exp_f32 v179, v179
  v_exp_f32 v180, v180
  v_exp_f32 v181, v181
  v_exp_f32_e64 v182, v182
  v_mfma_f32_32x32x16_bf16 v[160:175], v[200:203], v[24:27], v[64:79]
  v_exp_f32 v183, v183
  v_exp_f32 v184, v184
  v_exp_f32 v185, v185
  v_exp_f32 v186, v186
  v_exp_f32_e64 v187, v187
  v_smfmac_f32_32x32x32_bf16 v[112:127], v[220:223], v[176:183], v228
  v_exp_f32 v188, v188
  v_exp_f32 v189, v189
  v_exp_f32 v190, v190
  v_exp_f32 v191, v191
  v_exp_f32 v160, v160
  v_exp_f32 v161, v161
  v_smfmac_f32_32x32x32_bf16 v[112:127], v[224:227], v[184:191], v228
  v_exp_f32 v162, v162
  v_exp_f32 v163, v163
  v_exp_f32 v164, v164
  v_exp_f32 v165, v165
  v_exp_f32_e64 v166, v166
  v_mfma_f32_32x32x16_bf16 v[176:191], v[200:203], v[28:31], v[80:95]
  v_exp_f32 v167, v167
  v_exp_f32 v168, v168
  v_exp_f32 v169, v169
  v_exp_f32 v170, v170
  v_exp_f32_e64 v171, v171
  v_smfmac_f32_32x32x32_bf16 v[128:143], v[220:223], v[160:167], v228
  v_exp_f32 v172, v172
  v_exp_f32 v173, v173
  v_exp_f32 v174, v174
  v_exp_f32 v175, v175
  v_exp_f32 v176, v176
  v_exp_f32 v177, v177
  v_smfmac_f32_32x32x32_bf16 v[128:143], v[224:227], v[168:175], v228
  v_exp_f32 v178, v178
  v_exp_f32 v179, v179
  v_exp_f32 v180, v180
  v_exp_f32 v181, v181
  s_waitcnt vmcnt(4)
  v_exp_f32 v182, v182
  v_mfma_f32_32x32x16_bf16 v[160:175], v[192:195], v[16:19], v[32:47]
  v_exp_f32 v183, v183
  v_exp_f32 v184, v184
  v_exp_f32 v185, v185
  v_exp_f32 v186, v186
  v_exp_f32_e64 v187, v187
  v_smfmac_f32_32x32x32_bf16 v[144:159], v[220:223], v[176:183], v228
  v_exp_f32 v188, v188
  v_exp_f32 v189, v189
  v_exp_f32 v190, v190
  v_exp_f32 v191, v191
  v_exp_f32 v160, v160
  v_exp_f32 v161, v161
  v_smfmac_f32_32x32x32_bf16 v[144:159], v[224:227], v[184:191], v228
  v_exp_f32_e64 v162, v162
  s_add_u32 s64, s59, 5120
  s_add_u32 s65, s58, 5120
  s_mov_b64 exec, s[98:99]
  buffer_load_dwordx4 v[220:223], v229, s[40:43], s64 offen sc1
  buffer_load_dwordx4 v[224:227], v229, s[40:43], s64 offen offset:512 sc1
  s_mov_b64 exec, -1
  buffer_load_dwordx4 v[200:203], v4, s[40:43], s65 offen sc1
  v_exp_f32 v163, v163
  v_exp_f32 v164, v164
  v_exp_f32 v165, v165
  v_exp_f32 v166, v166
  v_mfma_f32_32x32x16_bf16 v[176:191], v[192:195], v[20:23], v[48:63]
  v_exp_f32 v167, v167
  v_exp_f32 v168, v168
  v_exp_f32 v169, v169
  v_exp_f32 v170, v170
  v_exp_f32_e64 v171, v171
  v_smfmac_f32_32x32x32_bf16 v[96:111], v[204:207], v[160:167], v228
  v_exp_f32 v172, v172
  v_exp_f32 v173, v173
  v_exp_f32 v174, v174
  v_exp_f32 v175, v175
  v_exp_f32 v176, v176
  v_exp_f32 v177, v177
  v_smfmac_f32_32x32x32_bf16 v[96:111], v[208:211], v[168:175], v228
  v_exp_f32 v178, v178
  v_exp_f32 v179, v179
  v_exp_f32 v180, v180
  v_exp_f32 v181, v181
  v_exp_f32_e64 v182, v182
  v_mfma_f32_32x32x16_bf16 v[160:175], v[192:195], v[24:27], v[64:79]
  v_exp_f32 v183, v183
  v_exp_f32 v184, v184
  v_exp_f32 v185, v185
  v_exp_f32 v186, v186
  v_exp_f32_e64 v187, v187
  v_smfmac_f32_32x32x32_bf16 v[112:127], v[204:207], v[176:183], v228
  v_exp_f32 v188, v188
  v_exp_f32 v189, v189
  v_exp_f32 v190, v190
  v_exp_f32 v191, v191
  v_exp_f32 v160, v160
  v_exp_f32 v161, v161
  v_smfmac_f32_32x32x32_bf16 v[112:127], v[208:211], v[184:191], v228
  v_exp_f32 v162, v162
  v_exp_f32 v163, v163
  v_exp_f32 v164, v164
  v_exp_f32 v165, v165
  v_exp_f32_e64 v166, v166
  v_mfma_f32_32x32x16_bf16 v[176:191], v[192:195], v[28:31], v[80:95]
  v_exp_f32 v167, v167
  v_exp_f32 v168, v168
  v_exp_f32 v169, v169
  v_exp_f32 v170, v170
  v_exp_f32_e64 v171, v171
  v_smfmac_f32_32x32x32_bf16 v[128:143], v[204:207], v[160:167], v228
  v_exp_f32 v172, v172
  v_exp_f32 v173, v173
  v_exp_f32 v174, v174
  v_exp_f32 v175, v175
  v_exp_f32 v176, v176
  v_exp_f32 v177, v177
  v_smfmac_f32_32x32x32_bf16 v[128:143], v[208:211], v[168:175], v228
  v_exp_f32 v178, v178
  v_exp_f32 v179, v179
  v_exp_f32 v180, v180
  v_exp_f32 v181, v181
  s_waitcnt vmcnt(3)
  v_exp_f32 v182, v182
  v_mfma_f32_32x32x16_bf16 v[160:175], v[196:199], v[16:19], v[32:47]
  v_exp_f32 v183, v183
  v_exp_f32 v184, v184
  v_exp_f32 v185, v185
  v_exp_f32 v186, v186
  v_exp_f32_e64 v187, v187
  v_smfmac_f32_32x32x32_bf16 v[144:159], v[204:207], v[176:183], v228
  v_exp_f32 v188, v188
  v_exp_f32 v189, v189
  v_exp_f32 v190, v190
  v_exp_f32 v191, v191
  v_exp_f32 v160, v160
  v_exp_f32 v161, v161
  v_smfmac_f32_32x32x32_bf16 v[144:159], v[208:211], v[184:191], v228
  v_exp_f32_e64 v162, v162
  s_add_u32 s64, s59, 6144
  s_add_u32 s65, s58, 6144
  s_mov_b64 exec, s[98:99]
  buffer_load_dwordx4 v[204:207], v229, s[40:43], s64 offen sc1
  buffer_load_dwordx4 v[208:211], v229, s[40:43], s64 offen offset:512 sc1
  s_mov_b64 exec, -1
  buffer_load_dwordx4 v[192:195], v4, s[40:43], s65 offen sc1
  v_exp_f32 v163, v163
  v_exp_f32 v164, v164
  v_exp_f32 v165, v165
  v_exp_f32 v166, v166
  v_mfma_f32_32x32x16_bf16 v[176:191], v[196:199], v[20:23], v[48:63]
  v_exp_f32 v167, v167
  v_exp_f32 v168, v168
  v_exp_f32 v169, v169
  v_exp_f32 v170, v170
  v_exp_f32_e64 v171, v171
  v_smfmac_f32_32x32x32_bf16 v[96:111], v[212:215], v[160:167], v228
  v_exp_f32 v172, v172
  v_exp_f32 v173, v173
  v_exp_f32 v174, v174
  v_exp_f32 v175, v175
  v_exp_f32 v176, v176
  v_exp_f32 v177, v177
  v_smfmac_f32_32x32x32_bf16 v[96:111], v[216:219], v[168:175], v228
  v_exp_f32_e64 v178, v178
  s_cmp_eq_u32 s46, 0
  s_cselect_b64 exec, -1, 0
  buffer_load_dword v247, v235, s[20:23], 0 offen
  s_mov_b64 exec, -1
  v_exp_f32 v179, v179
  v_exp_f32 v180, v180
  v_exp_f32 v181, v181
  v_exp_f32_e64 v182, v182
  v_mfma_f32_32x32x16_bf16 v[160:175], v[196:199], v[24:27], v[64:79]
  v_exp_f32 v183, v183
  v_exp_f32 v184, v184
  v_exp_f32 v185, v185
  v_exp_f32 v186, v186
  v_exp_f32_e64 v187, v187
  v_smfmac_f32_32x32x32_bf16 v[112:127], v[212:215], v[176:183], v228
  v_exp_f32 v188, v188
  v_exp_f32 v189, v189
  v_exp_f32 v190, v190
  v_exp_f32 v191, v191
  v_exp_f32 v160, v160
  v_exp_f32 v161, v161
  v_smfmac_f32_32x32x32_bf16 v[112:127], v[216:219], v[184:191], v228
  v_exp_f32 v162, v162
  v_exp_f32 v163, v163
  v_exp_f32 v164, v164
  v_exp_f32 v165, v165
  v_exp_f32_e64 v166, v166
  v_mfma_f32_32x32x16_bf16 v[176:191], v[196:199], v[28:31], v[80:95]
  v_exp_f32 v167, v167
  v_exp_f32 v168, v168
  v_exp_f32 v169, v169
  v_exp_f32 v170, v170
  v_exp_f32_e64 v171, v171
  v_smfmac_f32_32x32x32_bf16 v[128:143], v[212:215], v[160:167], v228
  v_exp_f32 v172, v172
  v_exp_f32 v173, v173
  v_exp_f32 v174, v174
  v_exp_f32 v175, v175
  v_exp_f32 v176, v176
  v_exp_f32 v177, v177
  v_smfmac_f32_32x32x32_bf16 v[128:143], v[216:219], v[168:175], v228
  v_exp_f32 v178, v178
  v_exp_f32 v179, v179
  v_exp_f32 v180, v180
  v_exp_f32 v181, v181
  s_waitcnt vmcnt(4)
  v_exp_f32 v182, v182
  v_mfma_f32_32x32x16_bf16 v[160:175], v[200:203], v[16:19], v[32:47]
  v_exp_f32 v183, v183
  v_exp_f32 v184, v184
  v_exp_f32 v185, v185
  v_exp_f32 v186, v186
  v_exp_f32_e64 v187, v187
  v_smfmac_f32_32x32x32_bf16 v[144:159], v[212:215], v[176:183], v228
  v_exp_f32 v188, v188
  v_exp_f32 v189, v189
  v_exp_f32 v190, v190
  v_exp_f32 v191, v191
  v_exp_f32 v160, v160
  v_exp_f32 v161, v161
  v_smfmac_f32_32x32x32_bf16 v[144:159], v[216:219], v[184:191], v228
  v_exp_f32_e64 v162, v162
  s_add_u32 s64, s59, 7168
  s_add_u32 s65, s58, 7168
  s_mov_b64 exec, s[98:99]
  buffer_load_dwordx4 v[212:215], v229, s[40:43], s64 offen sc1
  buffer_load_dwordx4 v[216:219], v229, s[40:43], s64 offen offset:512 sc1
  s_mov_b64 exec, -1
  buffer_load_dwordx4 v[196:199], v4, s[40:43], s65 offen sc1
  v_exp_f32 v163, v163
  v_exp_f32 v164, v164
  v_exp_f32 v165, v165
  v_exp_f32 v166, v166
  v_mfma_f32_32x32x16_bf16 v[176:191], v[200:203], v[20:23], v[48:63]
  v_exp_f32 v167, v167
  v_exp_f32 v168, v168
  v_exp_f32 v169, v169
  v_exp_f32 v170, v170
  v_exp_f32_e64 v171, v171
  v_smfmac_f32_32x32x32_bf16 v[96:111], v[220:223], v[160:167], v228
  v_exp_f32 v172, v172
  v_exp_f32 v173, v173
  v_exp_f32 v174, v174
  v_exp_f32 v175, v175
  v_exp_f32 v176, v176
  v_exp_f32 v177, v177
  v_smfmac_f32_32x32x32_bf16 v[96:111], v[224:227], v[168:175], v228
  v_exp_f32_e64 v178, v178
  s_cmp_eq_u32 s46, 1
  s_cselect_b64 exec, -1, 0
  buffer_load_dword v247, v235, s[20:23], 0 offen
  s_mov_b64 exec, -1
  v_exp_f32 v179, v179
  v_exp_f32 v180, v180
  v_exp_f32 v181, v181
  v_exp_f32_e64 v182, v182
  v_mfma_f32_32x32x16_bf16 v[160:175], v[200:203], v[24:27], v[64:79]
  v_exp_f32 v183, v183
  v_exp_f32 v184, v184
  v_exp_f32 v185, v185
  v_exp_f32 v186, v186
  v_exp_f32_e64 v187, v187
  v_smfmac_f32_32x32x32_bf16 v[112:127], v[220:223], v[176:183], v228
  v_exp_f32 v188, v188
  v_exp_f32 v189, v189
  v_exp_f32 v190, v190
  v_exp_f32 v191, v191
  v_exp_f32 v160, v160
  v_exp_f32 v161, v161
  v_smfmac_f32_32x32x32_bf16 v[112:127], v[224:227], v[184:191], v228
  v_exp_f32 v162, v162
  v_exp_f32 v163, v163
  v_exp_f32 v164, v164
  v_exp_f32 v165, v165
  v_exp_f32_e64 v166, v166
  v_mfma_f32_32x32x16_bf16 v[176:191], v[200:203], v[28:31], v[80:95]
  v_exp_f32 v167, v167
  v_exp_f32 v168, v168
  v_exp_f32 v169, v169
  v_exp_f32 v170, v170
  v_exp_f32_e64 v171, v171
  v_smfmac_f32_32x32x32_bf16 v[128:143], v[220:223], v[160:167], v228
  v_exp_f32 v172, v172
  v_exp_f32 v173, v173
  v_exp_f32 v174, v174
  v_exp_f32 v175, v175
  v_exp_f32 v176, v176
  v_exp_f32 v177, v177
  v_smfmac_f32_32x32x32_bf16 v[128:143], v[224:227], v[168:175], v228
  v_exp_f32 v178, v178
  v_exp_f32 v179, v179
  v_exp_f32 v180, v180
  v_exp_f32 v181, v181
  s_waitcnt vmcnt(5)
  v_exp_f32 v182, v182
  v_mfma_f32_32x32x16_bf16 v[160:175], v[192:195], v[16:19], v[32:47]
  v_exp_f32 v183, v183
  v_exp_f32 v184, v184
  v_exp_f32 v185, v185
  v_exp_f32 v186, v186
  v_exp_f32_e64 v187, v187
  v_smfmac_f32_32x32x32_bf16 v[144:159], v[220:223], v[176:183], v228
  v_exp_f32 v188, v188
  v_exp_f32 v189, v189
  v_exp_f32 v190, v190
  v_exp_f32 v191, v191
  v_exp_f32 v160, v160
  v_exp_f32 v161, v161
  v_smfmac_f32_32x32x32_bf16 v[144:159], v[224:227], v[184:191], v228
  v_exp_f32_e64 v162, v162
  s_add_u32 s64, s59, 8192
  s_add_u32 s65, s58, 8192
  s_mov_b64 exec, s[98:99]
  buffer_load_dwordx4 v[220:223], v229, s[40:43], s64 offen sc1
  buffer_load_dwordx4 v[224:227], v229, s[40:43], s64 offen offset:512 sc1
  s_mov_b64 exec, -1
  buffer_load_dwordx4 v[200:203], v4, s[40:43], s65 offen sc1
  v_exp_f32 v163, v163
  v_exp_f32 v164, v164
  v_exp_f32 v165, v165
  v_exp_f32 v166, v166
  v_mfma_f32_32x32x16_bf16 v[176:191], v[192:195], v[20:23], v[48:63]
  v_exp_f32 v167, v167
  v_exp_f32 v168, v168
  v_exp_f32 v169, v169
  v_exp_f32 v170, v170
  v_exp_f32_e64 v171, v171
  v_smfmac_f32_32x32x32_bf16 v[96:111], v[204:207], v[160:167], v228
  v_exp_f32 v172, v172
  v_exp_f32 v173, v173
  v_exp_f32 v174, v174
  v_exp_f32 v175, v175
  v_exp_f32 v176, v176
  v_exp_f32 v177, v177
  v_smfmac_f32_32x32x32_bf16 v[96:111], v[208:211], v[168:175], v228
  v_exp_f32_e64 v178, v178
  s_cmp_eq_u32 s46, 0
  s_cselect_b64 exec, -1, 0
  buffer_load_dword v247, v234, s[16:19], 0 offen
  s_mov_b64 exec, -1
  s_cmp_eq_u32 s46, 2
  s_cselect_b64 exec, -1, 0
  buffer_load_dword v247, v235, s[20:23], 0 offen
  s_mov_b64 exec, -1
  v_exp_f32 v179, v179
  v_exp_f32 v180, v180
  v_exp_f32 v181, v181
  v_exp_f32 v182, v182
  v_mfma_f32_32x32x16_bf16 v[160:175], v[192:195], v[24:27], v[64:79]
  v_exp_f32 v183, v183
  v_exp_f32 v184, v184
  v_exp_f32 v185, v185
  v_exp_f32 v186, v186
  v_exp_f32_e64 v187, v187
  v_smfmac_f32_32x32x32_bf16 v[112:127], v[204:207], v[176:183], v228
  v_exp_f32 v188, v188
  v_exp_f32 v189, v189
  v_exp_f32 v190, v190
  v_exp_f32 v191, v191
  v_exp_f32 v160, v160
  v_exp_f32 v161, v161
  v_smfmac_f32_32x32x32_bf16 v[112:127], v[208:211], v[184:191], v228
  v_exp_f32 v162, v162
  v_exp_f32 v163, v163
  v_exp_f32 v164, v164
  v_exp_f32 v165, v165
  v_exp_f32_e64 v166, v166
  v_mfma_f32_32x32x16_bf16 v[176:191], v[192:195], v[28:31], v[80:95]
  v_exp_f32 v167, v167
  v_exp_f32 v168, v168
  v_exp_f32 v169, v169
  v_exp_f32 v170, v170
  v_exp_f32_e64 v171, v171
  v_smfmac_f32_32x32x32_bf16 v[128:143], v[204:207], v[160:167], v228
  v_exp_f32 v172, v172
  v_exp_f32 v173, v173
  v_exp_f32 v174, v174
  v_exp_f32 v175, v175
  v_exp_f32 v176, v176
  v_exp_f32 v177, v177
  v_smfmac_f32_32x32x32_bf16 v[128:143], v[208:211], v[168:175], v228
  v_exp_f32 v178, v178
  v_exp_f32 v179, v179
  v_exp_f32 v180, v180
  v_exp_f32 v181, v181
  s_waitcnt vmcnt(6)
  v_exp_f32 v182, v182
  v_mfma_f32_32x32x16_bf16 v[160:175], v[196:199], v[16:19], v[32:47]
  v_exp_f32 v183, v183
  v_exp_f32 v184, v184
  v_exp_f32 v185, v185
  v_exp_f32 v186, v186
  v_exp_f32_e64 v187, v187
  v_smfmac_f32_32x32x32_bf16 v[144:159], v[204:207], v[176:183], v228
  v_exp_f32 v188, v188
  v_exp_f32 v189, v189
  v_exp_f32 v190, v190
  v_exp_f32 v191, v191
  v_exp_f32 v160, v160
  v_exp_f32 v161, v161
  v_smfmac_f32_32x32x32_bf16 v[144:159], v[208:211], v[184:191], v228
  v_exp_f32_e64 v162, v162
  s_add_u32 s64, s59, 9216
  s_add_u32 s65, s58, 9216
  s_mov_b64 exec, s[98:99]
  buffer_load_dwordx4 v[204:207], v229, s[40:43], s64 offen sc1
  buffer_load_dwordx4 v[208:211], v229, s[40:43], s64 offen offset:512 sc1
  s_mov_b64 exec, -1
  buffer_load_dwordx4 v[192:195], v4, s[40:43], s65 offen sc1
  v_exp_f32 v163, v163
  v_exp_f32 v164, v164
  v_exp_f32 v165, v165
  v_exp_f32 v166, v166
  v_mfma_f32_32x32x16_bf16 v[176:191], v[196:199], v[20:23], v[48:63]
  v_exp_f32 v167, v167
  v_exp_f32 v168, v168
  v_exp_f32 v169, v169
  v_exp_f32 v170, v170
  v_exp_f32_e64 v171, v171
  v_smfmac_f32_32x32x32_bf16 v[96:111], v[212:215], v[160:167], v228
  v_exp_f32 v172, v172
  v_exp_f32 v173, v173
  v_exp_f32 v174, v174
  v_exp_f32 v175, v175
  v_exp_f32 v176, v176
  v_exp_f32 v177, v177
  v_smfmac_f32_32x32x32_bf16 v[96:111], v[216:219], v[168:175], v228
  v_exp_f32_e64 v178, v178
  s_cmp_eq_u32 s46, 1
  s_cselect_b64 exec, -1, 0
  buffer_load_dword v247, v234, s[16:19], 0 offen
  s_mov_b64 exec, -1
  s_cmp_eq_u32 s46, 3
  s_cselect_b64 exec, -1, 0
  buffer_load_dword v247, v235, s[20:23], 0 offen
  s_mov_b64 exec, -1
  v_exp_f32 v179, v179
  v_exp_f32 v180, v180
  v_exp_f32 v181, v181
  v_exp_f32 v182, v182
  v_mfma_f32_32x32x16_bf16 v[160:175], v[196:199], v[24:27], v[64:79]
  v_exp_f32 v183, v183
  v_exp_f32 v184, v184
  v_exp_f32 v185, v185
  v_exp_f32 v186, v186
  v_exp_f32_e64 v187, v187
  v_smfmac_f32_32x32x32_bf16 v[112:127], v[212:215], v[176:183], v228
  v_exp_f32 v188, v188
  v_exp_f32 v189, v189
  v_exp_f32 v190, v190
  v_exp_f32 v191, v191
  v_exp_f32 v160, v160
  v_exp_f32 v161, v161
  v_smfmac_f32_32x32x32_bf16 v[112:127], v[216:219], v[184:191], v228
  v_exp_f32 v162, v162
  v_exp_f32 v163, v163
  v_exp_f32 v164, v164
  v_exp_f32 v165, v165
  v_exp_f32_e64 v166, v166
  v_mfma_f32_32x32x16_bf16 v[176:191], v[196:199], v[28:31], v[80:95]
  v_exp_f32 v167, v167
  v_exp_f32 v168, v168
  v_exp_f32 v169, v169
  v_exp_f32 v170, v170
  v_exp_f32_e64 v171, v171
  v_smfmac_f32_32x32x32_bf16 v[128:143], v[212:215], v[160:167], v228
  v_exp_f32 v172, v172
  v_exp_f32 v173, v173
  v_exp_f32 v174, v174
  v_exp_f32 v175, v175
  v_exp_f32 v176, v176
  v_exp_f32 v177, v177
  v_smfmac_f32_32x32x32_bf16 v[128:143], v[216:219], v[168:175], v228
  v_exp_f32 v178, v178
  v_exp_f32 v179, v179
  v_exp_f32 v180, v180
  v_exp_f32 v181, v181
  s_waitcnt vmcnt(7)
  v_exp_f32 v182, v182
  v_mfma_f32_32x32x16_bf16 v[160:175], v[200:203], v[16:19], v[32:47]
  v_exp_f32 v183, v183
  v_exp_f32 v184, v184
  v_exp_f32 v185, v185
  v_exp_f32 v186, v186
  v_exp_f32_e64 v187, v187
  v_smfmac_f32_32x32x32_bf16 v[144:159], v[212:215], v[176:183], v228
  v_exp_f32 v188, v188
  v_exp_f32 v189, v189
  v_exp_f32 v190, v190
  v_exp_f32 v191, v191
  s_setprio 2
  v_exp_f32 v160, v160
  v_exp_f32_e64 v161, v161
  v_smfmac_f32_32x32x32_bf16 v[144:159], v[216:219], v[184:191], v228
  v_exp_f32_e64 v162, v162
  s_add_u32 s64, s59, 10240
  s_add_u32 s65, s58, 10240
  s_mov_b64 exec, s[98:99]
  buffer_load_dwordx4 v[212:215], v229, s[40:43], s64 offen sc1
  buffer_load_dwordx4 v[216:219], v229, s[40:43], s64 offen offset:512 sc1
  s_mov_b64 exec, -1
  buffer_load_dwordx4 v[196:199], v4, s[40:43], s65 offen sc1
  v_exp_f32 v163, v163
  v_exp_f32 v164, v164
  v_exp_f32 v165, v165
  v_exp_f32 v166, v166
  v_mfma_f32_32x32x16_bf16 v[176:191], v[200:203], v[20:23], v[48:63]
  v_exp_f32 v167, v167
  v_exp_f32 v168, v168
  v_exp_f32 v169, v169
  v_exp_f32 v170, v170
  v_exp_f32_e64 v171, v171
  v_smfmac_f32_32x32x32_bf16 v[96:111], v[220:223], v[160:167], v228
  v_exp_f32 v172, v172
  v_exp_f32 v173, v173
  v_exp_f32 v174, v174
  v_exp_f32 v175, v175
  v_exp_f32 v176, v176
  v_exp_f32 v177, v177
  v_smfmac_f32_32x32x32_bf16 v[96:111], v[224:227], v[168:175], v228
  v_exp_f32 v178, v178
  s_lshl_b32 s97, s48, 1
  s_add_u32 s97, s97, 0
  s_and_b32 s97, s97, 7
  s_mul_i32 s97, s97, 176128
  s_add_u32 s97, s97, s93
  s_lshl_b32 s96, s46, 10
  s_add_u32 m0, s96, 65536
  s_nop 0
  buffer_load_dwordx4 v244, s[16:19], s97 offen lds
  s_sub_u32 s97, s97, s93
  s_add_u32 s97, s97, s92
  s_lshl_b32 s96, s46, 10
  s_add_u32 m0, s96, 73728
  s_nop 0
  buffer_load_dwordx4 v244, s[16:19], s97 offen lds
  s_sub_u32 s97, s97, s92
  s_lshl_b32 s96, s46, 10
  s_add_u32 m0, s96, 81920
  s_nop 0
  buffer_load_dwordx4 v245, s[16:19], s97 offen lds
  s_cmp_eq_u32 s46, 2
  s_cselect_b64 exec, -1, 0
  buffer_load_dword v247, v234, s[16:19], 0 offen
  s_mov_b64 exec, -1
  s_cmp_eq_u32 s46, 4
  s_cselect_b64 exec, -1, 0
  buffer_load_dword v247, v235, s[20:23], 0 offen
  s_mov_b64 exec, -1
  v_exp_f32 v179, v179
  v_exp_f32 v180, v180
  v_exp_f32 v181, v181
  v_exp_f32 v182, v182
  v_mfma_f32_32x32x16_bf16 v[160:175], v[200:203], v[24:27], v[64:79]
  v_exp_f32 v183, v183
  v_exp_f32 v184, v184
  v_exp_f32 v185, v185
  v_exp_f32 v186, v186
  v_exp_f32_e64 v187, v187
  v_smfmac_f32_32x32x32_bf16 v[112:127], v[220:223], v[176:183], v228
  v_exp_f32 v188, v188
  v_exp_f32 v189, v189
  v_exp_f32 v190, v190
  v_exp_f32 v191, v191
  v_exp_f32 v160, v160
  v_exp_f32 v161, v161
  v_smfmac_f32_32x32x32_bf16 v[112:127], v[224:227], v[184:191], v228
  v_exp_f32 v162, v162
  v_exp_f32 v163, v163
  v_exp_f32 v164, v164
  v_exp_f32 v165, v165
  v_exp_f32_e64 v166, v166
  v_mfma_f32_32x32x16_bf16 v[176:191], v[200:203], v[28:31], v[80:95]
  v_exp_f32 v167, v167
  v_exp_f32 v168, v168
  v_exp_f32 v169, v169
  v_exp_f32 v170, v170
  v_exp_f32_e64 v171, v171
  v_smfmac_f32_32x32x32_bf16 v[128:143], v[220:223], v[160:167], v228
  v_exp_f32 v172, v172
  v_exp_f32 v173, v173
  v_exp_f32 v174, v174
  v_exp_f32 v175, v175
  v_exp_f32 v176, v176
  v_exp_f32 v177, v177
  v_smfmac_f32_32x32x32_bf16 v[128:143], v[224:227], v[168:175], v228
  v_exp_f32 v178, v178
  v_exp_f32 v179, v179
  v_exp_f32 v180, v180
  v_exp_f32 v181, v181
  s_waitcnt vmcnt(10)
  v_exp_f32 v182, v182
  v_mfma_f32_32x32x16_bf16 v[160:175], v[192:195], v[16:19], v[32:47]
  v_exp_f32 v183, v183
  v_exp_f32 v184, v184
  v_exp_f32 v185, v185
  v_exp_f32 v186, v186
  v_exp_f32_e64 v187, v187
  v_smfmac_f32_32x32x32_bf16 v[144:159], v[220:223], v[176:183], v228
  v_exp_f32 v188, v188
  v_exp_f32 v189, v189
  v_exp_f32 v190, v190
  v_exp_f32 v191, v191
  v_exp_f32 v160, v160
  v_exp_f32 v161, v161
  v_smfmac_f32_32x32x32_bf16 v[144:159], v[224:227], v[184:191], v228
  v_exp_f32_e64 v162, v162
  s_add_u32 s64, s59, 11264
  s_add_u32 s65, s58, 11264
  s_mov_b64 exec, s[98:99]
  buffer_load_dwordx4 v[220:223], v229, s[40:43], s64 offen sc1
  buffer_load_dwordx4 v[224:227], v229, s[40:43], s64 offen offset:512 sc1
  s_mov_b64 exec, -1
  buffer_load_dwordx4 v[200:203], v4, s[40:43], s65 offen sc1
  v_exp_f32 v163, v163
  v_exp_f32 v164, v164
  v_exp_f32 v165, v165
  v_exp_f32 v166, v166
  v_mfma_f32_32x32x16_bf16 v[176:191], v[192:195], v[20:23], v[48:63]
  v_exp_f32 v167, v167
  v_exp_f32 v168, v168
  v_exp_f32 v169, v169
  v_exp_f32 v170, v170
  v_exp_f32_e64 v171, v171
  v_smfmac_f32_32x32x32_bf16 v[96:111], v[204:207], v[160:167], v228
  v_exp_f32 v172, v172
  v_exp_f32 v173, v173
  v_exp_f32 v174, v174
  v_exp_f32 v175, v175
  v_exp_f32 v176, v176
  v_exp_f32 v177, v177
  v_smfmac_f32_32x32x32_bf16 v[96:111], v[208:211], v[168:175], v228
  v_exp_f32_e64 v178, v178
  s_cmp_eq_u32 s46, 3
  s_cselect_b64 exec, -1, 0
  buffer_load_dword v247, v234, s[16:19], 0 offen
  s_mov_b64 exec, -1
  s_cmp_eq_u32 s46, 5
  s_cselect_b64 exec, -1, 0
  buffer_load_dword v247, v235, s[20:23], 0 offen
  s_mov_b64 exec, -1
  v_exp_f32 v179, v179
  v_exp_f32 v180, v180
  v_exp_f32 v181, v181
  v_exp_f32 v182, v182
  v_mfma_f32_32x32x16_bf16 v[160:175], v[192:195], v[24:27], v[64:79]
  v_exp_f32 v183, v183
  v_exp_f32 v184, v184
  v_exp_f32 v185, v185
  v_exp_f32 v186, v186
  v_exp_f32_e64 v187, v187
  v_smfmac_f32_32x32x32_bf16 v[112:127], v[204:207], v[176:183], v228
  v_exp_f32 v188, v188
  v_exp_f32 v189, v189
  v_exp_f32 v190, v190
  v_exp_f32 v191, v191
  v_exp_f32 v160, v160
  v_exp_f32 v161, v161
  v_smfmac_f32_32x32x32_bf16 v[112:127], v[208:211], v[184:191], v228
  v_exp_f32 v162, v162
  v_exp_f32 v163, v163
  v_exp_f32 v164, v164
  v_exp_f32 v165, v165
  v_exp_f32_e64 v166, v166
  v_mfma_f32_32x32x16_bf16 v[176:191], v[192:195], v[28:31], v[80:95]
  v_exp_f32 v167, v167
  v_exp_f32 v168, v168
  v_exp_f32 v169, v169
  v_exp_f32 v170, v170
  v_exp_f32_e64 v171, v171
  v_smfmac_f32_32x32x32_bf16 v[128:143], v[204:207], v[160:167], v228
  v_exp_f32 v172, v172
  v_exp_f32 v173, v173
  v_exp_f32 v174, v174
  v_exp_f32 v175, v175
  v_exp_f32 v176, v176
  v_exp_f32 v177, v177
  v_smfmac_f32_32x32x32_bf16 v[128:143], v[208:211], v[168:175], v228
  v_exp_f32 v178, v178
  v_exp_f32 v179, v179
  v_exp_f32 v180, v180
  v_exp_f32 v181, v181
  s_waitcnt vmcnt(10)
  v_exp_f32 v182, v182
  v_mfma_f32_32x32x16_bf16 v[160:175], v[196:199], v[16:19], v[32:47]
  v_exp_f32 v183, v183
  v_exp_f32 v184, v184
  v_exp_f32 v185, v185
  v_exp_f32 v186, v186
  v_exp_f32_e64 v187, v187
  v_smfmac_f32_32x32x32_bf16 v[144:159], v[204:207], v[176:183], v228
  v_exp_f32 v188, v188
  v_exp_f32 v189, v189
  v_exp_f32 v190, v190
  v_exp_f32 v191, v191
  v_exp_f32 v160, v160
  v_exp_f32 v161, v161
  v_smfmac_f32_32x32x32_bf16 v[144:159], v[208:211], v[184:191], v228
  v_exp_f32_e64 v162, v162
  s_add_u32 s64, s59, 12288
  s_add_u32 s65, s58, 12288
  s_mov_b64 exec, s[98:99]
  buffer_load_dwordx4 v[204:207], v229, s[40:43], s64 offen sc1
  buffer_load_dwordx4 v[208:211], v229, s[40:43], s64 offen offset:512 sc1
  s_mov_b64 exec, -1
  buffer_load_dwordx4 v[192:195], v4, s[40:43], s65 offen sc1
  v_exp_f32 v163, v163
  v_exp_f32 v164, v164
  v_exp_f32 v165, v165
  v_exp_f32 v166, v166
  v_mfma_f32_32x32x16_bf16 v[176:191], v[196:199], v[20:23], v[48:63]
  v_exp_f32 v167, v167
  v_exp_f32 v168, v168
  v_exp_f32 v169, v169
  v_exp_f32 v170, v170
  v_exp_f32_e64 v171, v171
  v_smfmac_f32_32x32x32_bf16 v[96:111], v[212:215], v[160:167], v228
  v_exp_f32 v172, v172
  v_exp_f32 v173, v173
  v_exp_f32 v174, v174
  v_exp_f32 v175, v175
  v_exp_f32 v176, v176
  v_exp_f32 v177, v177
  v_smfmac_f32_32x32x32_bf16 v[96:111], v[216:219], v[168:175], v228
  v_exp_f32_e64 v178, v178
  s_cmp_eq_u32 s46, 4
  s_cselect_b64 exec, -1, 0
  buffer_load_dword v247, v234, s[16:19], 0 offen
  s_mov_b64 exec, -1
  s_cmp_eq_u32 s46, 6
  s_cselect_b64 exec, -1, 0
  buffer_load_dword v247, v235, s[20:23], 0 offen
  s_mov_b64 exec, -1
  v_exp_f32 v179, v179
  v_exp_f32 v180, v180
  v_exp_f32 v181, v181
  v_exp_f32 v182, v182
  v_mfma_f32_32x32x16_bf16 v[160:175], v[196:199], v[24:27], v[64:79]
  v_exp_f32 v183, v183
  v_exp_f32 v184, v184
  v_exp_f32 v185, v185
  v_exp_f32 v186, v186
  v_exp_f32_e64 v187, v187
  v_smfmac_f32_32x32x32_bf16 v[112:127], v[212:215], v[176:183], v228
  v_exp_f32 v188, v188
  v_exp_f32 v189, v189
  v_exp_f32 v190, v190
  v_exp_f32 v191, v191
  v_exp_f32 v160, v160
  v_exp_f32 v161, v161
  v_smfmac_f32_32x32x32_bf16 v[112:127], v[216:219], v[184:191], v228
  v_exp_f32 v162, v162
  v_exp_f32 v163, v163
  v_exp_f32 v164, v164
  v_exp_f32 v165, v165
  v_exp_f32_e64 v166, v166
  v_mfma_f32_32x32x16_bf16 v[176:191], v[196:199], v[28:31], v[80:95]
  v_exp_f32 v167, v167
  v_exp_f32 v168, v168
  v_exp_f32 v169, v169
  v_exp_f32 v170, v170
  v_exp_f32_e64 v171, v171
  v_smfmac_f32_32x32x32_bf16 v[128:143], v[212:215], v[160:167], v228
  v_exp_f32 v172, v172
  v_exp_f32 v173, v173
  v_exp_f32 v174, v174
  v_exp_f32 v175, v175
  v_exp_f32 v176, v176
  v_exp_f32 v177, v177
  v_smfmac_f32_32x32x32_bf16 v[128:143], v[216:219], v[168:175], v228
  v_exp_f32 v178, v178
  v_exp_f32 v179, v179
  v_exp_f32 v180, v180
  v_exp_f32 v181, v181
  s_waitcnt vmcnt(7)
  v_exp_f32 v182, v182
  v_mfma_f32_32x32x16_bf16 v[160:175], v[200:203], v[16:19], v[32:47]
  v_exp_f32 v183, v183
  v_exp_f32 v184, v184
  v_exp_f32 v185, v185
  v_exp_f32 v186, v186
  v_exp_f32_e64 v187, v187
  v_smfmac_f32_32x32x32_bf16 v[144:159], v[212:215], v[176:183], v228
  v_exp_f32 v188, v188
  v_exp_f32 v189, v189
  v_exp_f32 v190, v190
  v_exp_f32 v191, v191
  v_exp_f32 v160, v160
  v_exp_f32 v161, v161
  v_smfmac_f32_32x32x32_bf16 v[144:159], v[216:219], v[184:191], v228
  v_exp_f32_e64 v162, v162
  s_add_u32 s64, s59, 13312
  s_add_u32 s65, s58, 13312
  s_mov_b64 exec, s[98:99]
  buffer_load_dwordx4 v[212:215], v229, s[40:43], s64 offen sc1
  buffer_load_dwordx4 v[216:219], v229, s[40:43], s64 offen offset:512 sc1
  s_mov_b64 exec, -1
  buffer_load_dwordx4 v[196:199], v4, s[40:43], s65 offen sc1
  v_exp_f32 v163, v163
  v_exp_f32 v164, v164
  v_exp_f32 v165, v165
  v_exp_f32 v166, v166
  v_mfma_f32_32x32x16_bf16 v[176:191], v[200:203], v[20:23], v[48:63]
  v_exp_f32 v167, v167
  v_exp_f32 v168, v168
  v_exp_f32 v169, v169
  v_exp_f32 v170, v170
  v_exp_f32_e64 v171, v171
  v_smfmac_f32_32x32x32_bf16 v[96:111], v[220:223], v[160:167], v228
  v_exp_f32 v172, v172
  v_exp_f32 v173, v173
  v_exp_f32 v174, v174
  v_exp_f32 v175, v175
  v_exp_f32 v176, v176
  v_exp_f32 v177, v177
  v_smfmac_f32_32x32x32_bf16 v[96:111], v[224:227], v[168:175], v228
  v_exp_f32_e64 v178, v178
  s_cmp_eq_u32 s46, 5
  s_cselect_b64 exec, -1, 0
  buffer_load_dword v247, v234, s[16:19], 0 offen
  s_mov_b64 exec, -1
  s_cmp_eq_u32 s46, 7
  s_cselect_b64 exec, -1, 0
  buffer_load_dword v247, v235, s[20:23], 0 offen
  s_mov_b64 exec, -1
  v_exp_f32 v179, v179
  v_exp_f32 v180, v180
  v_exp_f32 v181, v181
  v_exp_f32 v182, v182
  v_mfma_f32_32x32x16_bf16 v[160:175], v[200:203], v[24:27], v[64:79]
  v_exp_f32 v183, v183
  v_exp_f32 v184, v184
  v_exp_f32 v185, v185
  v_exp_f32 v186, v186
  v_exp_f32_e64 v187, v187
  v_smfmac_f32_32x32x32_bf16 v[112:127], v[220:223], v[176:183], v228
  v_exp_f32 v188, v188
  v_exp_f32 v189, v189
  v_exp_f32 v190, v190
  v_exp_f32 v191, v191
  v_exp_f32 v160, v160
  v_exp_f32 v161, v161
  v_smfmac_f32_32x32x32_bf16 v[112:127], v[224:227], v[184:191], v228
  v_exp_f32 v162, v162
  v_exp_f32 v163, v163
  v_exp_f32 v164, v164
  v_exp_f32 v165, v165
  v_exp_f32_e64 v166, v166
  v_mfma_f32_32x32x16_bf16 v[176:191], v[200:203], v[28:31], v[80:95]
  v_exp_f32 v167, v167
  v_exp_f32 v168, v168
  v_exp_f32 v169, v169
  v_exp_f32 v170, v170
  v_exp_f32_e64 v171, v171
  v_smfmac_f32_32x32x32_bf16 v[128:143], v[220:223], v[160:167], v228
  v_exp_f32 v172, v172
  v_exp_f32 v173, v173
  v_exp_f32 v174, v174
  v_exp_f32 v175, v175
  v_exp_f32 v176, v176
  v_exp_f32 v177, v177
  v_smfmac_f32_32x32x32_bf16 v[128:143], v[224:227], v[168:175], v228
  v_exp_f32 v178, v178
  v_exp_f32 v179, v179
  v_exp_f32 v180, v180
  v_exp_f32 v181, v181
  s_waitcnt vmcnt(7)
  v_exp_f32 v182, v182
  v_mfma_f32_32x32x16_bf16 v[160:175], v[192:195], v[16:19], v[32:47]
  v_exp_f32 v183, v183
  v_exp_f32 v184, v184
  v_exp_f32 v185, v185
  v_exp_f32 v186, v186
  v_exp_f32_e64 v187, v187
  v_smfmac_f32_32x32x32_bf16 v[144:159], v[220:223], v[176:183], v228
  v_exp_f32 v188, v188
  v_exp_f32 v189, v189
  v_exp_f32 v190, v190
  v_exp_f32 v191, v191
  s_setprio 1
  v_exp_f32 v160, v160
  v_exp_f32_e64 v161, v161
  v_smfmac_f32_32x32x32_bf16 v[144:159], v[224:227], v[184:191], v228
  v_exp_f32_e64 v162, v162
  s_add_u32 s64, s59, 14336
  s_add_u32 s65, s58, 14336
  s_mov_b64 exec, s[98:99]
  buffer_load_dwordx4 v[220:223], v229, s[40:43], s64 offen sc1
  buffer_load_dwordx4 v[224:227], v229, s[40:43], s64 offen offset:512 sc1
  s_mov_b64 exec, -1
  buffer_load_dwordx4 v[200:203], v4, s[40:43], s65 offen sc1
  v_exp_f32 v163, v163
  v_exp_f32 v164, v164
  v_exp_f32 v165, v165
  v_exp_f32 v166, v166
  v_mfma_f32_32x32x16_bf16 v[176:191], v[192:195], v[20:23], v[48:63]
  v_exp_f32 v167, v167
  v_exp_f32 v168, v168
  v_exp_f32 v169, v169
  v_exp_f32 v170, v170
  v_exp_f32_e64 v171, v171
  v_smfmac_f32_32x32x32_bf16 v[96:111], v[204:207], v[160:167], v228
  v_exp_f32 v172, v172
  v_exp_f32 v173, v173
  v_exp_f32 v174, v174
  v_exp_f32 v175, v175
  v_exp_f32 v176, v176
  v_exp_f32 v177, v177
  v_smfmac_f32_32x32x32_bf16 v[96:111], v[208:211], v[168:175], v228
  v_exp_f32_e64 v178, v178
  s_cmp_eq_u32 s46, 6
  s_cselect_b64 exec, -1, 0
  buffer_load_dword v247, v234, s[16:19], 0 offen
  s_mov_b64 exec, -1
  v_exp_f32 v179, v179
  v_exp_f32 v180, v180
  v_exp_f32 v181, v181
  v_exp_f32_e64 v182, v182
  v_mfma_f32_32x32x16_bf16 v[160:175], v[192:195], v[24:27], v[64:79]
  v_exp_f32 v183, v183
  v_exp_f32 v184, v184
  v_exp_f32 v185, v185
  v_exp_f32 v186, v186
  v_exp_f32_e64 v187, v187
  v_smfmac_f32_32x32x32_bf16 v[112:127], v[204:207], v[176:183], v228
  v_exp_f32 v188, v188
  v_exp_f32 v189, v189
  v_exp_f32 v190, v190
  v_exp_f32 v191, v191
  v_exp_f32 v160, v160
  v_exp_f32 v161, v161
  v_smfmac_f32_32x32x32_bf16 v[112:127], v[208:211], v[184:191], v228
  v_exp_f32 v162, v162
  v_exp_f32 v163, v163
  v_exp_f32 v164, v164
  v_exp_f32 v165, v165
  v_exp_f32_e64 v166, v166
  v_mfma_f32_32x32x16_bf16 v[176:191], v[192:195], v[28:31], v[80:95]
  v_exp_f32 v167, v167
  v_exp_f32 v168, v168
  v_exp_f32 v169, v169
  v_exp_f32 v170, v170
  v_exp_f32_e64 v171, v171
  v_smfmac_f32_32x32x32_bf16 v[128:143], v[204:207], v[160:167], v228
  v_exp_f32 v172, v172
  v_exp_f32 v173, v173
  v_exp_f32 v174, v174
  v_exp_f32 v175, v175
  v_exp_f32 v176, v176
  v_exp_f32 v177, v177
  v_smfmac_f32_32x32x32_bf16 v[128:143], v[208:211], v[168:175], v228
  v_exp_f32 v178, v178
  v_exp_f32 v179, v179
  v_exp_f32 v180, v180
  v_exp_f32 v181, v181
  s_waitcnt vmcnt(6)
  v_exp_f32 v182, v182
  v_mfma_f32_32x32x16_bf16 v[160:175], v[196:199], v[16:19], v[32:47]
  v_exp_f32 v183, v183
  v_exp_f32 v184, v184
  v_exp_f32 v185, v185
  v_exp_f32 v186, v186
  v_exp_f32_e64 v187, v187
  v_smfmac_f32_32x32x32_bf16 v[144:159], v[204:207], v[176:183], v228
  v_exp_f32 v188, v188
  v_exp_f32 v189, v189
  v_exp_f32 v190, v190
  v_exp_f32 v191, v191
  v_exp_f32 v160, v160
  v_exp_f32 v161, v161
  v_smfmac_f32_32x32x32_bf16 v[144:159], v[208:211], v[184:191], v228
  v_exp_f32_e64 v162, v162
  s_add_u32 s64, s59, 15360
  s_add_u32 s65, s58, 15360
  s_mov_b64 exec, s[98:99]
  buffer_load_dwordx4 v[204:207], v229, s[40:43], s64 offen sc1
  buffer_load_dwordx4 v[208:211], v229, s[40:43], s64 offen offset:512 sc1
  s_mov_b64 exec, -1
  buffer_load_dwordx4 v[192:195], v4, s[40:43], s65 offen sc1
  v_exp_f32 v163, v163
  v_exp_f32 v164, v164
  v_exp_f32 v165, v165
  v_exp_f32 v166, v166
  v_mfma_f32_32x32x16_bf16 v[176:191], v[196:199], v[20:23], v[48:63]
  v_exp_f32 v167, v167
  v_exp_f32 v168, v168
  v_exp_f32 v169, v169
  v_exp_f32 v170, v170
  v_exp_f32_e64 v171, v171
  v_smfmac_f32_32x32x32_bf16 v[96:111], v[212:215], v[160:167], v228
  v_exp_f32 v172, v172
  v_exp_f32 v173, v173
  v_exp_f32 v174, v174
  v_exp_f32 v175, v175
  v_exp_f32 v176, v176
  v_exp_f32 v177, v177
  v_smfmac_f32_32x32x32_bf16 v[96:111], v[216:219], v[168:175], v228
  v_exp_f32_e64 v178, v178
  s_cmp_eq_u32 s46, 7
  s_cselect_b64 exec, -1, 0
  buffer_load_dword v247, v234, s[16:19], 0 offen
  s_mov_b64 exec, -1
  v_exp_f32 v179, v179
  v_exp_f32 v180, v180
  v_exp_f32 v181, v181
  v_exp_f32_e64 v182, v182
  v_mfma_f32_32x32x16_bf16 v[160:175], v[196:199], v[24:27], v[64:79]
  v_exp_f32 v183, v183
  v_exp_f32 v184, v184
  v_exp_f32 v185, v185
  v_exp_f32 v186, v186
  v_exp_f32_e64 v187, v187
  v_smfmac_f32_32x32x32_bf16 v[112:127], v[212:215], v[176:183], v228
  v_exp_f32 v188, v188
  v_exp_f32 v189, v189
  v_exp_f32 v190, v190
  v_exp_f32 v191, v191
  v_exp_f32 v160, v160
  v_exp_f32 v161, v161
  v_smfmac_f32_32x32x32_bf16 v[112:127], v[216:219], v[184:191], v228
  v_exp_f32 v162, v162
  v_exp_f32 v163, v163
  v_exp_f32 v164, v164
  v_exp_f32 v165, v165
  v_exp_f32_e64 v166, v166
  v_mfma_f32_32x32x16_bf16 v[176:191], v[196:199], v[28:31], v[80:95]
  v_exp_f32 v167, v167
  v_exp_f32 v168, v168
  v_exp_f32 v169, v169
  v_exp_f32 v170, v170
  v_exp_f32_e64 v171, v171
  v_smfmac_f32_32x32x32_bf16 v[128:143], v[212:215], v[160:167], v228
  v_exp_f32 v172, v172
  v_exp_f32 v173, v173
  v_exp_f32 v174, v174
  v_exp_f32 v175, v175
  v_exp_f32 v176, v176
  v_exp_f32 v177, v177
  v_smfmac_f32_32x32x32_bf16 v[128:143], v[216:219], v[168:175], v228
  v_exp_f32 v178, v178
  v_exp_f32 v179, v179
  v_exp_f32 v180, v180
  v_exp_f32 v181, v181
  s_waitcnt vmcnt(5)
  v_exp_f32 v182, v182
  v_mfma_f32_32x32x16_bf16 v[160:175], v[200:203], v[16:19], v[32:47]
  v_exp_f32 v183, v183
  v_exp_f32 v184, v184
  v_exp_f32 v185, v185
  v_exp_f32 v186, v186
  v_exp_f32_e64 v187, v187
  v_smfmac_f32_32x32x32_bf16 v[144:159], v[212:215], v[176:183], v228
  v_exp_f32 v188, v188
  v_exp_f32 v189, v189
  v_exp_f32 v190, v190
  v_exp_f32 v191, v191
  s_cmp_ge_u32 s46, 4
  s_cbranch_scc1 L_pr_30
  s_setprio 0
L_pr_30:
  v_exp_f32 v160, v160
  v_exp_f32_e64 v161, v161
  v_smfmac_f32_32x32x32_bf16 v[144:159], v[216:219], v[184:191], v228
  v_exp_f32 v162, v162
  v_exp_f32 v163, v163
  v_exp_f32 v164, v164
  v_exp_f32 v165, v165
  v_exp_f32_e64 v166, v166
  v_mfma_f32_32x32x16_bf16 v[176:191], v[200:203], v[20:23], v[48:63]
  v_exp_f32 v167, v167
  v_exp_f32 v168, v168
  v_exp_f32 v169, v169
  v_exp_f32 v170, v170
  v_exp_f32_e64 v171, v171
  v_smfmac_f32_32x32x32_bf16 v[96:111], v[220:223], v[160:167], v228
  v_exp_f32 v172, v172
  v_exp_f32 v173, v173
  v_exp_f32 v174, v174
  v_exp_f32 v175, v175
  v_exp_f32 v176, v176
  v_exp_f32 v177, v177
  v_smfmac_f32_32x32x32_bf16 v[96:111], v[224:227], v[168:175], v228
  v_exp_f32 v178, v178
  v_exp_f32 v179, v179
  v_exp_f32 v180, v180
  v_exp_f32 v181, v181
  v_exp_f32_e64 v182, v182
  v_mfma_f32_32x32x16_bf16 v[160:175], v[200:203], v[24:27], v[64:79]
  v_exp_f32 v183, v183
  v_exp_f32 v184, v184
  v_exp_f32 v185, v185
  v_exp_f32 v186, v186
  v_exp_f32_e64 v187, v187
  v_smfmac_f32_32x32x32_bf16 v[112:127], v[220:223], v[176:183], v228
  v_exp_f32 v188, v188
  v_exp_f32 v189, v189
  v_exp_f32 v190, v190
  v_exp_f32 v191, v191
  v_exp_f32 v160, v160
  v_exp_f32 v161, v161
  v_smfmac_f32_32x32x32_bf16 v[112:127], v[224:227], v[184:191], v228
  v_exp_f32 v162, v162
  v_exp_f32 v163, v163
  v_exp_f32 v164, v164
  v_exp_f32 v165, v165
  v_exp_f32_e64 v166, v166
  v_mfma_f32_32x32x16_bf16 v[176:191], v[200:203], v[28:31], v[80:95]
  v_exp_f32 v167, v167
  v_exp_f32 v168, v168
  v_exp_f32 v169, v169
  v_exp_f32 v170, v170
  v_exp_f32_e64 v171, v171
  v_smfmac_f32_32x32x32_bf16 v[128:143], v[220:223], v[160:167], v228
  v_exp_f32 v172, v172
  v_exp_f32 v173, v173
  v_exp_f32 v174, v174
  v_exp_f32 v175, v175
  v_exp_f32 v176, v176
  v_exp_f32 v177, v177
  v_smfmac_f32_32x32x32_bf16 v[128:143], v[224:227], v[168:175], v228
  v_exp_f32 v178, v178
  v_exp_f32 v179, v179
  v_exp_f32 v180, v180
  v_exp_f32 v181, v181
  s_waitcnt vmcnt(1)
  v_exp_f32 v182, v182
  v_mfma_f32_32x32x16_bf16 v[160:175], v[192:195], v[16:19], v[32:47]
  v_exp_f32 v183, v183
  v_exp_f32 v184, v184
  v_exp_f32 v185, v185
  v_exp_f32 v186, v186
  v_exp_f32_e64 v187, v187
  v_smfmac_f32_32x32x32_bf16 v[144:159], v[220:223], v[176:183], v228
  v_exp_f32 v188, v188
  v_exp_f32 v189, v189
  v_exp_f32 v190, v190
  v_exp_f32 v191, v191
  v_exp_f32 v160, v160
  v_exp_f32 v161, v161
  v_smfmac_f32_32x32x32_bf16 v[144:159], v[224:227], v[184:191], v228
  v_exp_f32 v162, v162
  v_exp_f32 v163, v163
  v_exp_f32 v164, v164
  v_exp_f32 v165, v165
  v_exp_f32_e64 v166, v166
  v_mfma_f32_32x32x16_bf16 v[176:191], v[192:195], v[20:23], v[48:63]
  v_exp_f32 v167, v167
  v_exp_f32 v168, v168
  v_exp_f32 v169, v169
  v_exp_f32 v170, v170
  v_exp_f32_e64 v171, v171
  v_smfmac_f32_32x32x32_bf16 v[96:111], v[204:207], v[160:167], v228
  v_exp_f32 v172, v172
  v_exp_f32 v173, v173
  v_exp_f32 v174, v174
  v_exp_f32 v175, v175
  s_cmp_lt_u32 s46, 4
  s_cbranch_scc1 L_pr_31
  s_setprio 0
L_pr_31:
  v_exp_f32 v176, v176
  v_exp_f32_e64 v177, v177
  v_smfmac_f32_32x32x32_bf16 v[96:111], v[208:211], v[168:175], v228
  v_exp_f32 v178, v178
  v_exp_f32 v179, v179
  v_exp_f32 v180, v180
  v_exp_f32 v181, v181
  v_exp_f32_e64 v182, v182
  v_mfma_f32_32x32x16_bf16 v[160:175], v[192:195], v[24:27], v[64:79]
  v_exp_f32 v183, v183
  v_exp_f32 v184, v184
  v_exp_f32 v185, v185
  v_exp_f32 v186, v186
  v_exp_f32_e64 v187, v187
  v_smfmac_f32_32x32x32_bf16 v[112:127], v[204:207], v[176:183], v228
  v_exp_f32 v188, v188
  v_exp_f32 v189, v189
  ds_write_b128 v12, v[96:99]
  ds_write_b128 v12, v[100:103] offset:1024
  ds_write_b32 v5, v104 offset:2048
  v_exp_f32 v190, v190
  v_exp_f32 v191, v191
  v_exp_f32 v160, v160
  v_exp_f32 v161, v161
  v_smfmac_f32_32x32x32_bf16 v[112:127], v[208:211], v[184:191], v228
  v_exp_f32 v162, v162
  v_exp_f32 v163, v163
  v_exp_f32 v164, v164
  v_exp_f32 v165, v165
  v_exp_f32_e64 v166, v166
  v_mfma_f32_32x32x16_bf16 v[176:191], v[192:195], v[28:31], v[80:95]
  v_exp_f32 v167, v167
  v_exp_f32 v168, v168
  v_exp_f32 v169, v169
  v_exp_f32 v170, v170
  v_exp_f32_e64 v171, v171
  v_smfmac_f32_32x32x32_bf16 v[128:143], v[204:207], v[160:167], v228
  v_exp_f32 v172, v172
  v_exp_f32 v173, v173
  ds_write_b128 v13, v[112:115]
  ds_write_b128 v13, v[116:119] offset:1024
  ds_write_b32 v6, v120 offset:2048
  v_exp_f32 v174, v174
  v_exp_f32 v175, v175
  v_exp_f32 v176, v176
  v_exp_f32 v177, v177
  v_smfmac_f32_32x32x32_bf16 v[128:143], v[208:211], v[168:175], v228
  v_exp_f32 v178, v178
  v_exp_f32 v179, v179
  v_exp_f32 v180, v180
  v_exp_f32 v181, v181
  v_exp_f32 v182, v182
  v_exp_f32 v183, v183
  v_exp_f32 v184, v184
  v_exp_f32 v185, v185
  v_exp_f32 v186, v186
  v_exp_f32 v187, v187
  v_smfmac_f32_32x32x32_bf16 v[144:159], v[204:207], v[176:183], v228
  v_exp_f32 v188, v188
  v_exp_f32 v189, v189
  ds_write_b128 v14, v[128:131]
  ds_write_b128 v14, v[132:135] offset:1024
  ds_write_b32 v7, v136 offset:2048
  v_exp_f32 v190, v190
  v_exp_f32_e64 v191, v191
  s_nop 1
  v_smfmac_f32_32x32x32_bf16 v[144:159], v[208:211], v[184:191], v228
  s_setprio 0
  s_nop 10
  v_mov_b32_e64 v7, v152
  s_nop 1
  v_permlane32_swap_b32 v152, v7
  s_waitcnt lgkmcnt(0)
  s_barrier
  ds_read_b32 v168, v10 offset:2048
  ds_read_b32 v180, v10 offset:4352
  ds_read_b32 v192, v10 offset:6656
  ds_read_b128 v[160:163], v9 offset:0
  ds_read_b128 v[164:167], v9 offset:1024
  ds_read_b128 v[172:175], v9 offset:2304
  ds_read_b128 v[176:179], v9 offset:3328
  ds_read_b128 v[184:187], v9 offset:4608
  ds_read_b128 v[188:191], v9 offset:5632
  s_waitcnt lgkmcnt(6)
  v_add_f32 v152, v152, v168
  v_add_f32 v152, v152, v180
  v_add_f32 v152, v152, v192
  v_mov_b32 v6, 0x6c800000
  v_rcp_f32_e64 v8, v152
  v_cmp_nlt_f32 s[66:67], v152, v6
  v_mov_b32 v6, 0x21800000
  v_cmp_ngt_f32 s[68:69], v152, v6
  s_waitcnt lgkmcnt(4)
  v_pk_add_f32 v[144:145], v[144:145], v[160:161]
  v_pk_add_f32 v[146:147], v[146:147], v[162:163]
  v_pk_add_f32 v[148:149], v[148:149], v[164:165]
  v_pk_add_f32 v[150:151], v[150:151], v[166:167]
  s_waitcnt lgkmcnt(2)
  v_pk_add_f32 v[144:145], v[144:145], v[172:173]
  v_pk_add_f32 v[146:147], v[146:147], v[174:175]
  v_pk_add_f32 v[148:149], v[148:149], v[176:177]
  v_pk_add_f32 v[150:151], v[150:151], v[178:179]
  s_waitcnt lgkmcnt(0)
  v_pk_add_f32 v[144:145], v[144:145], v[184:185]
  v_pk_add_f32 v[146:147], v[146:147], v[186:187]
  v_pk_add_f32 v[148:149], v[148:149], v[188:189]
  v_pk_add_f32 v[150:151], v[150:151], v[190:191]
  v_mul_f32 v144, v144, v8
  v_mul_f32 v145, v145, v8
  v_mul_f32 v146, v146, v8
  v_mul_f32 v147, v147, v8
  v_mul_f32 v148, v148, v8
  v_mul_f32 v149, v149, v8
  v_mul_f32 v150, v150, v8
  v_mul_f32_e64 v151, v151, v8
  v_cvt_pk_bf16_f32 v12, v144, v145
  v_cvt_pk_bf16_f32 v13, v146, v147
  v_cvt_pk_bf16_f32 v14, v148, v149
  v_cvt_pk_bf16_f32 v15, v150, v151
  buffer_store_dwordx4 v[12:15], v11, s[40:43], s61 offen sc1
  v_add_f32 v7, |v144|, |v145|
  v_add_f32 v7, v7, |v146|
  v_add_f32 v7, v7, |v147|
  v_add_f32 v7, v7, |v148|
  v_add_f32 v7, v7, |v149|
  v_add_f32 v7, v7, |v150|
  v_add_f32 v7, v7, |v151|
  v_mov_b32 v6, 0x7f800000
  v_cmp_nlt_f32 vcc, v7, v6
  v_mov_b32 v5, 90112
  s_or_b64 vcc, vcc, s[66:67]
  s_or_b64 vcc, vcc, s[68:69]
  s_cbranch_vccz L_nobad_32
  ds_write_b32 v5, v228
L_nobad_32:
  v_and_b32 v5, 15, v1
  v_lshrrev_b32 v6, 4, v1
  v_and_b32 v7, 1, v6
  v_lshrrev_b32 v69, 2, v5
  v_lshl_add_u32 v69, v7, 2, v69
  v_and_b32_e64 v7, 6, v69
  v_bfe_u32 v68, v5, 1, 1
  s_and_b32 s64, s46, 4
  v_add_u32 v68, s64, v68
  v_xor_b32 v68, v68, v7
  v_lshlrev_b32 v68, 4, v68
  v_lshl_add_u32 v68, v69, 7, v68
  v_and_b32_e64 v7, 1, v5
  v_lshl_add_u32 v68, v7, 3, v68
  v_lshrrev_b32_e64 v6, 1, v6
  v_lshl_add_u32 v68, v6, 11, v68
  v_add_u32 v68, 98304, v68
  v_xor_b32 v69, 32, v68
  v_and_b32 v5, 15, v1
  v_lshrrev_b32 v6, 4, v1
  v_lshlrev_b32 v70, 10, v5
  v_lshl_add_u32 v70, v6, 3, v70
  s_and_b32 s72, s46, 3
  s_lshl_b32 s72, s72, 14
  v_add_u32 v71, s72, v4
  s_lshl_b32 s73, s50, 16
  s_add_u32 s72, s72, s73
  s_lshl_b32 s73, s49, 7
  s_add_u32 s72, s72, s73
  s_lshr_b32 s73, s46, 2
  s_lshl_b32 s73, s73, 6
  s_add_u32 s63, s72, s73
  s_waitcnt vmcnt(0) lgkmcnt(0)
  s_barrier
  v_mov_b32 v5, 90112
  ds_read_b32 v6, v5
  s_waitcnt lgkmcnt(0)
  v_readfirstlane_b32 s64, v6
  s_cmp_lg_u32 s64, 0
  s_cselect_b32 s64, 1, 0
  s_cmp_gt_u32 s64, s54
  s_cbranch_scc1 L_att_fallback
  s_cmp_lg_u32 s46, 0
  s_cbranch_scc1 L_w0_33
  s_mov_b64 exec, 0x2
  buffer_store_dword v3, v2, s[40:43], 0 offen sc1
  s_mov_b64 exec, -1
L_w0_33:
  buffer_load_dwordx2 v[60:61], v70, s[4:7], s63 offen
  buffer_load_dwordx2 v[62:63], v70, s[4:7], s63 offen offset:32
  v_lshrrev_b32 v5, 3, v1
  v_and_b32 v6, 7, v1
  v_lshrrev_b32 v7, 1, v5
  v_xor_b32 v6, v6, v7
  v_lshlrev_b32_e64 v6, 4, v6
  v_lshl_add_u32 v100, v5, 12, v6
  v_xor_b32 v101, 64, v100
  s_lshl_b32 s57, s50, 1
  s_and_b32 s64, s46, 1
  s_add_u32 s57, s57, s64
  s_lshl_b32 s57, s57, 17
  s_lshr_b32 s64, s46, 1
  s_lshl_b32 s64, s64, 10
  s_add_u32 s57, s57, s64
  s_lshl_b32 s58, s46, 13
  s_add_u32 s62, s57, 0
  s_add_u32 m0, s58, 0
  s_nop 0
  buffer_load_dwordx4 v100, s[20:23], s62 offen lds
  s_add_u32 s62, s62, 32768
  s_add_u32 m0, s58, 1024
  s_nop 0
  buffer_load_dwordx4 v101, s[20:23], s62 offen lds
  s_add_u32 s62, s62, 32768
  s_add_u32 m0, s58, 2048
  s_nop 0
  buffer_load_dwordx4 v100, s[20:23], s62 offen lds
  s_add_u32 s62, s62, 32768
  s_add_u32 m0, s58, 3072
  s_nop 0
  buffer_load_dwordx4 v101, s[20:23], s62 offen lds
  s_add_u32 s62, s57, 128
  s_add_u32 m0, s58, 4096
  s_nop 0
  buffer_load_dwordx4 v100, s[20:23], s62 offen lds
  s_add_u32 s62, s62, 32768
  s_add_u32 m0, s58, 5120
  s_nop 0
  buffer_load_dwordx4 v101, s[20:23], s62 offen lds
  s_add_u32 s62, s62, 32768
  s_add_u32 m0, s58, 6144
  s_nop 0
  buffer_load_dwordx4 v100, s[20:23], s62 offen lds
  s_add_u32 s62, s62, 32768
  s_add_u32 m0, s58, 7168
  s_nop 0
  buffer_load_dwordx4 v101, s[20:23], s62 offen lds
  v_and_b32 v5, 31, v1
  v_lshrrev_b32_e64 v6, 5, v1
  v_bfe_u32 v7, v5, 1, 3
  v_xor_b32 v6, v6, v7
  v_lshlrev_b32 v6, 4, v6
  v_lshl_add_u32 v6, v5, 7, v6
  v_add_u32 v102, s58, v6
  v_xor_b32 v103, 32, v102
  v_xor_b32_e64 v104, 64, v102
  v_xor_b32 v105, 96, v102
  s_waitcnt vmcnt(4)
  ds_read_b128 v[116:119], v102 offset:0
  ds_read_b128 v[120:123], v103 offset:0
  ds_read_b128 v[124:127], v104 offset:0
  ds_read_b128 v[128:131], v105 offset:0
  s_waitcnt vmcnt(0)
  ds_read_b128 v[132:135], v102 offset:4096
  ds_read_b128 v[136:139], v103 offset:4096
  ds_read_b128 v[140:143], v104 offset:4096
  ds_read_b128 v[144:147], v105 offset:4096
  s_waitcnt lgkmcnt(0)
  s_lshr_b32 s64, s46, 1
  s_lshl_b32 s64, s64, 4
  s_and_b32 s65, s46, 1
  s_add_u32 s64, s64, s65
  s_lshl_b32 s59, s64, 10
  s_lshl_b32 s56, s50, 16
  s_add_u32 s56, s56, s59
  s_add_u32 s56, s56, 2097152
  v_lshlrev_b32 v8, 5, v1
  s_lshl_b32 s64, s44, 10
  v_add_u32 v8, s64, v8
  v_and_b32 v5, 7, v1
  v_bfe_u32 v6, v1, 3, 2
  v_lshlrev_b32_e64 v5, 10, v5
  v_lshl_add_u32 v5, v6, 5, v5
  s_lshl_b32 s64, s44, 7
  v_add_u32_e64 v5, s64, v5
  v_cmp_gt_u32 vcc, 32, v1
  s_nop 1
  v_cndmask_b32 v8, v5, v8, vcc
  s_cmp_lg_u32 s46, 1
  s_cbranch_scc1 L_w0_34
  s_mov_b32 s96, 24576
  s_mov_b32 s3, 131072
L_poll_35:
  buffer_load_dword v6, v8, s[40:43], s96 offen sc1
  s_waitcnt vmcnt(0)
  v_cmp_ne_u32 vcc, v6, v3
  s_cbranch_vccz L_pok_36
  s_sub_u32 s3, s3, 1
  s_cmp_lg_u32 s3, 0
  s_cbranch_scc1 L_poll_35
L_pok_36:
  s_mov_b64 exec, -1
L_w0_34:
  s_barrier
  s_add_u32 s64, s49, 0
  s_and_b32 s64, s64, 7
  s_lshl_b32 s64, s64, 11
  s_add_u32 m0, s59, 0
  s_add_u32 s64, s64, s56
  buffer_load_dwordx4 v4, s[40:43], s64 offen sc1 lds
  s_add_u32 s64, s49, 1
  s_and_b32 s64, s64, 7
  s_lshl_b32 s64, s64, 11
  s_add_u32 m0, s59, 2048
  s_add_u32 s64, s64, s56
  buffer_load_dwordx4 v4, s[40:43], s64 offen sc1 lds
  s_barrier
  s_add_u32 s64, s49, 2
  s_and_b32 s64, s64, 7
  s_lshl_b32 s64, s64, 11
  s_add_u32 m0, s59, 4096
  s_add_u32 s64, s64, s56
  buffer_load_dwordx4 v4, s[40:43], s64 offen sc1 lds
  s_add_u32 s64, s49, 3
  s_and_b32 s64, s64, 7
  s_lshl_b32 s64, s64, 11
  s_add_u32 m0, s59, 6144
  s_add_u32 s64, s64, s56
  buffer_load_dwordx4 v4, s[40:43], s64 offen sc1 lds
  s_add_u32 s64, s49, 4
  s_and_b32 s64, s64, 7
  s_lshl_b32 s64, s64, 11
  s_add_u32 m0, s59, 8192
  s_add_u32 s64, s64, s56
  buffer_load_dwordx4 v4, s[40:43], s64 offen sc1 lds
  s_barrier
  s_add_u32 s64, s49, 5
  s_and_b32 s64, s64, 7
  s_lshl_b32 s64, s64, 11
  s_add_u32 m0, s59, 10240
  s_add_u32 s64, s64, s56
  buffer_load_dwordx4 v4, s[40:43], s64 offen sc1 lds
  s_add_u32 s64, s49, 6
  s_and_b32 s64, s64, 7
  s_lshl_b32 s64, s64, 11
  s_add_u32 m0, s59, 12288
  s_add_u32 s64, s64, s56
  buffer_load_dwordx4 v4, s[40:43], s64 offen sc1 lds
  s_add_u32 s64, s49, 7
  s_and_b32 s64, s64, 7
  s_lshl_b32 s64, s64, 11
  s_add_u32 m0, s59, 14336
  s_add_u32 s64, s64, s56
  buffer_load_dwordx4 v4, s[40:43], s64 offen sc1 lds
  v_and_b32 v5, 15, v1
  v_bfe_u32 v6, v1, 4, 1
  v_lshlrev_b32_e64 v5, 3, v5
  v_lshl_add_u32 v14, v6, 2, v5
  s_and_b32 s64, s46, 3
  s_lshr_b32 s67, s46, 2
  s_lshl_b32 s65, s48, 4
  s_lshl_b32 s68, s49, 1
  s_add_u32 s68, s68, s67
  s_add_u32 s65, s65, s68
  s_lshl_b32 s65, s65, 9
  s_lshl_b32 s66, s64, 7
  s_add_u32 s65, s65, s66
  s_add_u32 s65, s65, s101
  s_add_u32 s65, s65, 786432
  s_lshl_b32 s66, s48, 2
  s_add_u32 s66, s66, s64
  s_lshl_b32 s66, s66, 4
  s_add_u32 s66, s66, s68
  s_lshl_b32 s66, s66, 10
  s_add_u32 s66, s66, s101
  s_waitcnt vmcnt(6)
  s_barrier
  ds_read_b128 v[24:27], v71 offset:0
  ds_read_b64_tr_b16 v[28:29], v68 offset:0
  ds_read_b64_tr_b16 v[30:31], v68 offset:1024
  ds_read_b64_tr_b16 v[32:33], v69 offset:0
  ds_read_b64_tr_b16 v[34:35], v69 offset:1024
  ds_read_b128 v[36:39], v71 offset:1024
  ds_read_b64_tr_b16 v[40:41], v68 offset:4096
  ds_read_b64_tr_b16 v[42:43], v68 offset:5120
  ds_read_b64_tr_b16 v[44:45], v69 offset:4096
  ds_read_b64_tr_b16 v[46:47], v69 offset:5120
  s_waitcnt lgkmcnt(5)
  v_mfma_f32_16x16x32_bf16 v[16:19], v[28:31], v[24:27], 0
  ds_read_b128 v[48:51], v71 offset:2048
  ds_read_b64_tr_b16 v[52:53], v68 offset:8192
  ds_read_b64_tr_b16 v[54:55], v68 offset:9216
  v_mfma_f32_16x16x32_bf16 v[20:23], v[32:35], v[24:27], 0
  ds_read_b64_tr_b16 v[56:57], v69 offset:8192
  ds_read_b64_tr_b16 v[58:59], v69 offset:9216
  s_waitcnt lgkmcnt(5)
  v_mfma_f32_16x16x32_bf16 v[16:19], v[40:43], v[36:39], v[16:19]
  ds_read_b128 v[24:27], v71 offset:3072
  ds_read_b64_tr_b16 v[28:29], v68 offset:12288
  ds_read_b64_tr_b16 v[30:31], v68 offset:13312
  v_mfma_f32_16x16x32_bf16 v[20:23], v[44:47], v[36:39], v[20:23]
  ds_read_b64_tr_b16 v[32:33], v69 offset:12288
  ds_read_b64_tr_b16 v[34:35], v69 offset:13312
  s_waitcnt vmcnt(3)
  s_barrier
  s_waitcnt lgkmcnt(5)
  v_mfma_f32_16x16x32_bf16 v[16:19], v[52:55], v[48:51], v[16:19]
  ds_read_b128 v[36:39], v71 offset:4096
  ds_read_b64_tr_b16 v[40:41], v68 offset:16384
  ds_read_b64_tr_b16 v[42:43], v68 offset:17408
  v_mfma_f32_16x16x32_bf16 v[20:23], v[56:59], v[48:51], v[20:23]
  ds_read_b64_tr_b16 v[44:45], v69 offset:16384
  ds_read_b64_tr_b16 v[46:47], v69 offset:17408
  s_waitcnt lgkmcnt(5)
  v_mfma_f32_16x16x32_bf16 v[16:19], v[28:31], v[24:27], v[16:19]
  ds_read_b128 v[48:51], v71 offset:5120
  ds_read_b64_tr_b16 v[52:53], v68 offset:20480
  ds_read_b64_tr_b16 v[54:55], v68 offset:21504
  v_mfma_f32_16x16x32_bf16 v[20:23], v[32:35], v[24:27], v[20:23]
  ds_read_b64_tr_b16 v[56:57], v69 offset:20480
  ds_read_b64_tr_b16 v[58:59], v69 offset:21504
  s_waitcnt lgkmcnt(5)
  v_mfma_f32_16x16x32_bf16 v[16:19], v[40:43], v[36:39], v[16:19]
  ds_read_b128 v[24:27], v71 offset:6144
  ds_read_b64_tr_b16 v[28:29], v68 offset:24576
  ds_read_b64_tr_b16 v[30:31], v68 offset:25600
  v_mfma_f32_16x16x32_bf16 v[20:23], v[44:47], v[36:39], v[20:23]
  ds_read_b64_tr_b16 v[32:33], v69 offset:24576
  ds_read_b64_tr_b16 v[34:35], v69 offset:25600
  s_waitcnt lgkmcnt(5)
  v_mfma_f32_16x16x32_bf16 v[16:19], v[52:55], v[48:51], v[16:19]
  ds_read_b128 v[36:39], v71 offset:7168
  ds_read_b64_tr_b16 v[40:41], v68 offset:28672
  ds_read_b64_tr_b16 v[42:43], v68 offset:29696
  v_mfma_f32_16x16x32_bf16 v[20:23], v[56:59], v[48:51], v[20:23]
  ds_read_b64_tr_b16 v[44:45], v69 offset:28672
  ds_read_b64_tr_b16 v[46:47], v69 offset:29696
  s_waitcnt lgkmcnt(5)
  v_mfma_f32_16x16x32_bf16 v[16:19], v[28:31], v[24:27], v[16:19]
  ds_read_b128 v[48:51], v71 offset:8192
  ds_read_b64_tr_b16 v[52:53], v68 offset:32768
  ds_read_b64_tr_b16 v[54:55], v68 offset:33792
  v_mfma_f32_16x16x32_bf16 v[20:23], v[32:35], v[24:27], v[20:23]
  ds_read_b64_tr_b16 v[56:57], v69 offset:32768
  ds_read_b64_tr_b16 v[58:59], v69 offset:33792
  s_waitcnt lgkmcnt(5)
  v_mfma_f32_16x16x32_bf16 v[16:19], v[40:43], v[36:39], v[16:19]
  ds_read_b128 v[24:27], v71 offset:9216
  ds_read_b64_tr_b16 v[28:29], v68 offset:36864
  ds_read_b64_tr_b16 v[30:31], v68 offset:37888
  v_mfma_f32_16x16x32_bf16 v[20:23], v[44:47], v[36:39], v[20:23]
  ds_read_b64_tr_b16 v[32:33], v69 offset:36864
  ds_read_b64_tr_b16 v[34:35], v69 offset:37888
  s_waitcnt vmcnt(0)
  s_barrier
  s_waitcnt lgkmcnt(5)
  v_mfma_f32_16x16x32_bf16 v[16:19], v[52:55], v[48:51], v[16:19]
  ds_read_b128 v[36:39], v71 offset:10240
  ds_read_b64_tr_b16 v[40:41], v68 offset:40960
  ds_read_b64_tr_b16 v[42:43], v68 offset:41984
  ds_read_b64_tr_b16 v[44:45], v69 offset:40960
  ds_read_b64_tr_b16 v[46:47], v69 offset:41984
  v_mfma_f32_16x16x32_bf16 v[20:23], v[56:59], v[48:51], v[20:23]
  s_lshr_b32 s72, s46, 1
  s_lshl_b32 s72, s72, 14
  s_and_b32 s73, s46, 1
  s_lshl_b32 s73, s73, 12
  s_add_u32 s72, s72, s73
  s_sub_u32 s73, s72, s58
  s_mov_b32 s58, s72
  v_add_u32 v102, s73, v102
  v_add_u32 v103, s73, v103
  v_add_u32 v104, s73, v104
  v_add_u32 v105, s73, v105
  s_add_u32 s62, s57, 256
  s_add_u32 m0, s58, 0
  s_nop 0
  buffer_load_dwordx4 v100, s[20:23], s62 offen lds
  s_add_u32 s62, s62, 32768
  s_add_u32 m0, s58, 1024
  s_nop 0
  buffer_load_dwordx4 v101, s[20:23], s62 offen lds
  s_add_u32 s62, s62, 32768
  s_add_u32 m0, s58, 2048
  s_nop 0
  buffer_load_dwordx4 v100, s[20:23], s62 offen lds
  s_add_u32 s62, s62, 32768
  s_add_u32 m0, s58, 3072
  s_nop 0
  buffer_load_dwordx4 v101, s[20:23], s62 offen lds
  s_waitcnt lgkmcnt(5)
  v_mfma_f32_16x16x32_bf16 v[16:19], v[28:31], v[24:27], v[16:19]
  ds_read_b128 v[48:51], v71 offset:11264
  ds_read_b64_tr_b16 v[52:53], v68 offset:45056
  ds_read_b64_tr_b16 v[54:55], v68 offset:46080
  v_mfma_f32_16x16x32_bf16 v[20:23], v[32:35], v[24:27], v[20:23]
  ds_read_b64_tr_b16 v[56:57], v69 offset:45056
  ds_read_b64_tr_b16 v[58:59], v69 offset:46080
  s_waitcnt lgkmcnt(5)
  v_mfma_f32_16x16x32_bf16 v[16:19], v[40:43], v[36:39], v[16:19]
  ds_read_b128 v[24:27], v71 offset:12288
  ds_read_b64_tr_b16 v[28:29], v68 offset:49152
  ds_read_b64_tr_b16 v[30:31], v68 offset:50176
  v_mfma_f32_16x16x32_bf16 v[20:23], v[44:47], v[36:39], v[20:23]
  ds_read_b64_tr_b16 v[32:33], v69 offset:49152
  ds_read_b64_tr_b16 v[34:35], v69 offset:50176
  s_waitcnt lgkmcnt(5)
  v_mfma_f32_16x16x32_bf16 v[16:19], v[52:55], v[48:51], v[16:19]
  ds_read_b128 v[36:39], v71 offset:13312
  ds_read_b64_tr_b16 v[40:41], v68 offset:53248
  ds_read_b64_tr_b16 v[42:43], v68 offset:54272
  v_mfma_f32_16x16x32_bf16 v[20:23], v[56:59], v[48:51], v[20:23]
  ds_read_b64_tr_b16 v[44:45], v69 offset:53248
  ds_read_b64_tr_b16 v[46:47], v69 offset:54272
  s_waitcnt lgkmcnt(5)
  v_mfma_f32_16x16x32_bf16 v[16:19], v[28:31], v[24:27], v[16:19]
  ds_read_b128 v[48:51], v71 offset:14336
  ds_read_b64_tr_b16 v[52:53], v68 offset:57344
  ds_read_b64_tr_b16 v[54:55], v68 offset:58368
  v_mfma_f32_16x16x32_bf16 v[20:23], v[32:35], v[24:27], v[20:23]
  ds_read_b64_tr_b16 v[56:57], v69 offset:57344
  ds_read_b64_tr_b16 v[58:59], v69 offset:58368
  s_waitcnt lgkmcnt(5)
  v_mfma_f32_16x16x32_bf16 v[16:19], v[40:43], v[36:39], v[16:19]
  ds_read_b128 v[24:27], v71 offset:15360
  ds_read_b64_tr_b16 v[28:29], v68 offset:61440
  ds_read_b64_tr_b16 v[30:31], v68 offset:62464
  v_mfma_f32_16x16x32_bf16 v[20:23], v[44:47], v[36:39], v[20:23]
  ds_read_b64_tr_b16 v[32:33], v69 offset:61440
  ds_read_b64_tr_b16 v[34:35], v69 offset:62464
  s_waitcnt lgkmcnt(5)
  v_mfma_f32_16x16x32_bf16 v[16:19], v[52:55], v[48:51], v[16:19]
  v_mfma_f32_16x16x32_bf16 v[20:23], v[56:59], v[48:51], v[20:23]
  s_waitcnt lgkmcnt(0)
  v_mfma_f32_16x16x32_bf16 v[16:19], v[28:31], v[24:27], v[16:19]
  v_mfma_f32_16x16x32_bf16 v[20:23], v[32:35], v[24:27], v[20:23]
  v_lshlrev_b32 v24, 16, v60
  v_and_b32 v25, s55, v60
  v_lshlrev_b32 v26, 16, v61
  v_and_b32 v27, s55, v61
  v_lshlrev_b32 v28, 16, v62
  v_and_b32 v29, s55, v62
  v_lshlrev_b32 v30, 16, v63
  v_and_b32 v31, s55, v63
  v_pk_add_f32 v[248:249], v[16:17], v[24:25]
  v_pk_add_f32 v[250:251], v[18:19], v[26:27]
  v_pk_add_f32 v[252:253], v[20:21], v[28:29]
  v_pk_add_f32 v[254:255], v[22:23], v[30:31]
  v_cvt_pk_bf16_f32 v64, v248, v249
  v_cvt_pk_bf16_f32 v65, v250, v251
  v_cvt_pk_bf16_f32 v66, v252, v253
  v_cvt_pk_bf16_f32 v67, v254, v255
  buffer_store_dwordx4 v[64:67], v4, s[40:43], s66 offen
  v_add_f32 v12, v248, v249
  v_mul_f32 v13, v248, v248
  v_fmac_f32 v13, v249, v249
  v_add_f32 v12, v12, v250
  v_fmac_f32 v13, v250, v250
  v_add_f32 v12, v12, v251
  v_fmac_f32 v13, v251, v251
  v_add_f32 v12, v12, v252
  v_fmac_f32 v13, v252, v252
  v_add_f32 v12, v12, v253
  v_fmac_f32 v13, v253, v253
  v_add_f32 v12, v12, v254
  v_fmac_f32 v13, v254, v254
  v_add_f32 v12, v12, v255
  v_fmac_f32 v13, v255, v255
  s_nop 1
  v_permlane16_swap_b32 v12, v13
  v_add_f32 v12, v12, v13
  v_mov_b32 v13, v12
  s_nop 1
  v_permlane32_swap_b32 v12, v13
  v_add_f32 v12, v12, v13
  s_mov_b32 exec_lo, 0xffffffff
  s_mov_b32 exec_hi, 0x0
  buffer_store_dword v12, v14, s[40:43], s65 offen
  s_mov_b64 exec, -1
  v_and_b32 v5, 15, v1
  v_lshrrev_b32 v6, 4, v1
  v_and_b32 v7, 1, v6
  v_lshrrev_b32_e64 v9, 2, v5
  v_lshl_add_u32 v9, v7, 2, v9
  v_and_b32_e64 v7, 6, v9
  v_bfe_u32 v8, v5, 1, 1
  s_and_b32 s64, s46, 6
  v_add_u32 v8, s64, v8
  v_xor_b32 v8, v8, v7
  v_lshlrev_b32 v8, 4, v8
  v_lshl_add_u32 v8, v9, 7, v8
  v_and_b32_e64 v7, 1, v5
  v_lshl_add_u32 v8, v7, 3, v8
  v_lshrrev_b32_e64 v7, 1, v6
  v_lshl_add_u32 v8, v7, 10, v8
  v_add_u32 v8, 65536, v8
  v_add_u32 v9, 49152, v8
  s_and_b32 s64, s46, 1
  s_lshl_b32 s65, s64, 15
  v_add_u32 v10, s65, v4
  v_lshlrev_b32 v15, 3, v5
  v_lshl_add_u32 v15, v6, 11, v15
  s_lshr_b32 s59, s46, 1
  v_mul_u32_u24 v13, 208, v5
  v_lshl_add_u32 v13, v6, 3, v13
  s_mul_i32 s65, s64, 6656
  v_add_u32 v13, s65, v13
  v_lshrrev_b32 v5, 3, v1
  v_and_b32 v6, 7, v1
  v_lshrrev_b32 v7, 1, v5
  v_xor_b32 v6, v6, v7
  v_lshlrev_b32_e64 v6, 4, v6
  v_lshl_add_u32 v11, v5, 12, v6
  v_xor_b32_e64 v12, 64, v11
  s_lshl_b32 s57, s50, 1
  s_and_b32 s64, s46, 1
  s_add_u32 s57, s57, s64
  s_lshl_b32 s57, s57, 17
  s_lshr_b32 s64, s46, 1
  s_lshl_b32 s64, s64, 10
  s_add_u32 s57, s57, s64
  s_lshl_b32 s58, s46, 12
  s_add_u32 s58, s58, 65536
  s_waitcnt vmcnt(0)
  s_waitcnt lgkmcnt(0)
  s_barrier
  s_cmp_lg_u32 s46, 0
  s_cbranch_scc1 L_w0_37
  s_mov_b64 exec, 0x4
  s_cmp_eq_u32 s47, 0
  s_cbranch_scc1 L_sigw_38
  buffer_store_dword v3, v2, s[40:43], 0 offen
  s_branch L_sigd_39
L_sigw_38:
  buffer_wbl2 sc1
  s_waitcnt vmcnt(0)
  buffer_store_dword v3, v2, s[40:43], 0 offen sc1
L_sigd_39:
  s_mov_b64 exec, -1
L_w0_37:
  ds_read_b128 v[148:151], v102 offset:0
  ds_read_b128 v[152:155], v103 offset:0
  ds_read_b128 v[156:159], v104 offset:0
  ds_read_b128 v[160:163], v105 offset:0
  s_waitcnt lgkmcnt(0)
  s_and_b32 s64, s46, 3
  s_lshl_b32 s65, s48, 13
  s_lshl_b32 s66, s64, 7
  s_add_u32 s65, s65, s66
  s_add_u32 s65, s65, s101
  s_add_u32 s65, s65, 786432
  s_lshl_b32 s67, s64, 4
  s_lshr_b32 s68, s46, 2
  s_lshl_b32 s68, s68, 3
  s_add_u32 s67, s67, s68
  s_lshl_b32 s67, s67, 10
  s_lshl_b32 s70, s48, 2
  s_add_u32 s68, s68, s70
  s_add_u32 s69, s68, 4
  s_lshl_b32 s70, s48, 2
  s_add_u32 s70, s70, s64
  s_lshl_b32 s70, s70, 14
  s_add_u32 s70, s70, s101
  s_and_b32 s68, s68, 15
  s_lshl_b32 s68, s68, 10
  s_add_u32 s68, s68, s70
  s_and_b32 s69, s69, 15
  s_lshl_b32 s69, s69, 10
  s_add_u32 s69, s69, s70
  v_add_u32 v14, s67, v4
  s_lshl_b32 s56, s46, 10
  s_cmp_lg_u32 s46, 0
  s_cbranch_scc1 L_w0_40
  s_lshl_b32 s96, s50, 7
  s_add_u32 s96, s96, 12288
  v_lshlrev_b32_e64 v5, 2, v1
  s_mov_b64 exec, 0xff
  s_mov_b32 s3, 131072
L_poll_41:
  buffer_load_dword v6, v5, s[40:43], s96 offen sc1
  s_waitcnt vmcnt(0)
  v_cmp_ne_u32 vcc, v6, v3
  s_cbranch_vccz L_pok_42
  s_sub_u32 s3, s3, 1
  s_cmp_lg_u32 s3, 0
  s_cbranch_scc1 L_poll_41
L_pok_42:
  s_mov_b64 exec, -1
  s_cmp_lg_u32 s47, 0
  s_cbranch_scc1 L_acq_43
  buffer_inv sc1
  s_waitcnt vmcnt(0)
L_acq_43:
  s_branch L_w0d_44
L_w0_40:
  s_cmp_lg_u32 s46, 1
  s_cbranch_scc1 L_px_45
  v_subrev_u32 v46, 22016, v244
  v_subrev_u32 v47, 22016, v245
  s_lshl_b32 s97, s48, 1
  s_add_u32 s97, s97, 1
  s_and_b32 s97, s97, 7
  s_mul_i32 s97, s97, 176128
  s_add_u32 s97, s97, s93
  s_mov_b32 m0, 90112
  s_nop 0
  buffer_load_dwordx4 v46, s[16:19], s97 offen lds
  s_sub_u32 s97, s97, s93
  s_add_u32 s97, s97, s92
  s_mov_b32 m0, 98304
  s_nop 0
  buffer_load_dwordx4 v46, s[16:19], s97 offen lds
  s_sub_u32 s97, s97, s92
  s_mov_b32 m0, 106496
  s_nop 0
  buffer_load_dwordx4 v47, s[16:19], s97 offen lds
  s_lshl_b32 s97, s48, 1
  s_add_u32 s97, s97, 2
  s_and_b32 s97, s97, 7
  s_mul_i32 s97, s97, 176128
  s_add_u32 s97, s97, s93
  s_mov_b32 m0, 114688
  s_nop 0
  buffer_load_dwordx4 v46, s[16:19], s97 offen lds
  s_sub_u32 s97, s97, s93
  s_add_u32 s97, s97, s92
  s_mov_b32 m0, 122880
  s_nop 0
  buffer_load_dwordx4 v46, s[16:19], s97 offen lds
  s_sub_u32 s97, s97, s92
  s_mov_b32 m0, 131072
  s_nop 0
  buffer_load_dwordx4 v47, s[16:19], s97 offen lds
L_px_45:
  s_lshl_b32 s97, s48, 1
  s_add_u32 s97, s97, 1
  s_and_b32 s97, s97, 7
  s_mul_i32 s97, s97, 176128
  s_add_u32 s97, s97, s93
  s_add_u32 m0, s56, 90112
  s_nop 0
  buffer_load_dwordx4 v244, s[16:19], s97 offen lds
  s_sub_u32 s97, s97, s93
  s_add_u32 s97, s97, s92
  s_add_u32 m0, s56, 98304
  s_nop 0
  buffer_load_dwordx4 v244, s[16:19], s97 offen lds
  s_sub_u32 s97, s97, s92
  s_add_u32 m0, s56, 106496
  s_nop 0
  buffer_load_dwordx4 v245, s[16:19], s97 offen lds
  s_lshl_b32 s97, s48, 1
  s_add_u32 s97, s97, 2
  s_and_b32 s97, s97, 7
  s_mul_i32 s97, s97, 176128
  s_add_u32 s97, s97, s93
  s_add_u32 m0, s56, 114688
  s_nop 0
  buffer_load_dwordx4 v244, s[16:19], s97 offen lds
  s_sub_u32 s97, s97, s93
  s_add_u32 s97, s97, s92
  s_add_u32 m0, s56, 122880
  s_nop 0
  buffer_load_dwordx4 v244, s[16:19], s97 offen lds
  s_sub_u32 s97, s97, s92
  s_add_u32 m0, s56, 131072
  s_nop 0
  buffer_load_dwordx4 v245, s[16:19], s97 offen lds
L_w0d_44:
  s_barrier
  buffer_load_dwordx2 v[88:89], v15, s[40:43], s65 offen offset:0 sc1
  buffer_load_dwordx2 v[90:91], v15, s[40:43], s65 offen offset:512 sc1
  buffer_load_dwordx2 v[92:93], v15, s[40:43], s65 offen offset:1024 sc1
  buffer_load_dwordx2 v[94:95], v15, s[40:43], s65 offen offset:1536 sc1
  s_barrier
  buffer_load_dwordx4 v[56:59], v4, s[40:43], s68 offen offset:0 sc1
  buffer_load_dwordx4 v[60:63], v4, s[40:43], s68 offen offset:1024 sc1
  s_barrier
  buffer_load_dwordx4 v[64:67], v4, s[40:43], s68 offen offset:2048 sc1
  buffer_load_dwordx4 v[68:71], v4, s[40:43], s68 offen offset:3072 sc1
  s_waitcnt vmcnt(4)
  v_pk_add_f32 v[88:89], v[88:89], v[90:91]
  v_pk_add_f32 v[92:93], v[92:93], v[94:95]
  v_pk_add_f32 v[40:41], v[88:89], v[92:93]
  s_nop 1
  v_permlane16_swap_b32 v40, v41
  v_add_f32 v40, v40, v41
  v_mov_b32 v41, v40
  s_nop 1
  v_permlane32_swap_b32 v40, v41
  v_add_f32 v40, v40, v41
  v_mov_b32_e64 v41, v40
  s_nop 1
  v_permlane16_swap_b32 v40, v41
  v_mul_f32 v40, 0x3b000000, v40
  v_mul_f32 v41, 0x3b000000, v41
  v_fma_f32 v41, -v40, v40, v41
  v_max_f32_e64 v41, 0, v41
  v_add_f32 v41, 0x3727c5ac, v41
  v_rsq_f32 v42, v41
  v_sub_f32 v40, 0, v40
  v_mul_f32 v44, v40, v42
  v_mov_b32 v43, v42
  v_mov_b32 v45, v44
  s_barrier
  buffer_load_dwordx4 v[72:75], v4, s[40:43], s69 offen offset:0 sc1
  buffer_load_dwordx4 v[76:79], v4, s[40:43], s69 offen offset:1024 sc1
  s_barrier
  buffer_load_dwordx4 v[80:83], v4, s[40:43], s69 offen offset:2048 sc1
  buffer_load_dwordx4 v[84:87], v4, s[40:43], s69 offen offset:3072 sc1
  s_waitcnt vmcnt(7)
  v_lshlrev_b32 v48, 16, v56
  v_and_b32 v49, s55, v56
  v_lshlrev_b32 v50, 16, v57
  v_and_b32 v51, s55, v57
  v_lshlrev_b32 v52, 16, v58
  v_and_b32 v53, s55, v58
  v_lshlrev_b32 v54, 16, v59
  v_and_b32 v55, s55, v59
  v_pk_fma_f32 v[48:49], v[48:49], v[42:43], v[44:45]
  v_pk_fma_f32 v[50:51], v[50:51], v[42:43], v[44:45]
  v_pk_fma_f32 v[52:53], v[52:53], v[42:43], v[44:45]
  v_pk_fma_f32 v[54:55], v[54:55], v[42:43], v[44:45]
  v_cvt_pk_bf16_f32 v56, v48, v49
  v_cvt_pk_bf16_f32 v57, v50, v51
  v_cvt_pk_bf16_f32 v58, v52, v53
  v_cvt_pk_bf16_f32 v59, v54, v55
  ds_write_b128 v14, v[56:59] offset:0
  s_waitcnt vmcnt(6)
  v_lshlrev_b32 v48, 16, v60
  v_and_b32 v49, s55, v60
  v_lshlrev_b32 v50, 16, v61
  v_and_b32 v51, s55, v61
  v_lshlrev_b32 v52, 16, v62
  v_and_b32 v53, s55, v62
  v_lshlrev_b32 v54, 16, v63
  v_and_b32_e64 v55, s55, v63
  v_pk_fma_f32 v[48:49], v[48:49], v[42:43], v[44:45]
  v_pk_fma_f32 v[50:51], v[50:51], v[42:43], v[44:45]
  v_pk_fma_f32 v[52:53], v[52:53], v[42:43], v[44:45]
  v_pk_fma_f32 v[54:55], v[54:55], v[42:43], v[44:45]
  v_cvt_pk_bf16_f32 v60, v48, v49
  v_cvt_pk_bf16_f32 v61, v50, v51
  v_cvt_pk_bf16_f32 v62, v52, v53
  v_cvt_pk_bf16_f32 v63, v54, v55
  ds_write_b128 v14, v[60:63] offset:1024
  s_waitcnt vmcnt(5)
  v_lshlrev_b32 v48, 16, v64
  v_and_b32 v49, s55, v64
  v_lshlrev_b32 v50, 16, v65
  v_and_b32 v51, s55, v65
  v_lshlrev_b32 v52, 16, v66
  v_and_b32 v53, s55, v66
  v_lshlrev_b32 v54, 16, v67
  v_and_b32_e64 v55, s55, v67
  v_pk_fma_f32 v[48:49], v[48:49], v[42:43], v[44:45]
  v_pk_fma_f32 v[50:51], v[50:51], v[42:43], v[44:45]
  v_pk_fma_f32 v[52:53], v[52:53], v[42:43], v[44:45]
  v_pk_fma_f32 v[54:55], v[54:55], v[42:43], v[44:45]
  v_cvt_pk_bf16_f32 v64, v48, v49
  v_cvt_pk_bf16_f32 v65, v50, v51
  v_cvt_pk_bf16_f32 v66, v52, v53
  v_cvt_pk_bf16_f32 v67, v54, v55
  ds_write_b128 v14, v[64:67] offset:2048
  s_waitcnt vmcnt(4)
  v_lshlrev_b32 v48, 16, v68
  v_and_b32 v49, s55, v68
  v_lshlrev_b32 v50, 16, v69
  v_and_b32 v51, s55, v69
  v_lshlrev_b32 v52, 16, v70
  v_and_b32 v53, s55, v70
  v_lshlrev_b32 v54, 16, v71
  v_and_b32_e64 v55, s55, v71
  v_pk_fma_f32 v[48:49], v[48:49], v[42:43], v[44:45]
  v_pk_fma_f32 v[50:51], v[50:51], v[42:43], v[44:45]
  v_pk_fma_f32 v[52:53], v[52:53], v[42:43], v[44:45]
  v_pk_fma_f32 v[54:55], v[54:55], v[42:43], v[44:45]
  v_cvt_pk_bf16_f32 v68, v48, v49
  v_cvt_pk_bf16_f32 v69, v50, v51
  v_cvt_pk_bf16_f32 v70, v52, v53
  v_cvt_pk_bf16_f32 v71, v54, v55
  ds_write_b128 v14, v[68:71] offset:3072
  s_waitcnt vmcnt(3)
  v_lshlrev_b32 v48, 16, v72
  v_and_b32 v49, s55, v72
  v_lshlrev_b32 v50, 16, v73
  v_and_b32 v51, s55, v73
  v_lshlrev_b32 v52, 16, v74
  v_and_b32 v53, s55, v74
  v_lshlrev_b32 v54, 16, v75
  v_and_b32_e64 v55, s55, v75
  v_pk_fma_f32 v[48:49], v[48:49], v[42:43], v[44:45]
  v_pk_fma_f32 v[50:51], v[50:51], v[42:43], v[44:45]
  v_pk_fma_f32 v[52:53], v[52:53], v[42:43], v[44:45]
  v_pk_fma_f32 v[54:55], v[54:55], v[42:43], v[44:45]
  v_cvt_pk_bf16_f32 v72, v48, v49
  v_cvt_pk_bf16_f32 v73, v50, v51
  v_cvt_pk_bf16_f32 v74, v52, v53
  v_cvt_pk_bf16_f32 v75, v54, v55
  ds_write_b128 v14, v[72:75] offset:4096
  s_waitcnt vmcnt(2)
  v_lshlrev_b32 v48, 16, v76
  v_and_b32 v49, s55, v76
  v_lshlrev_b32 v50, 16, v77
  v_and_b32 v51, s55, v77
  v_lshlrev_b32 v52, 16, v78
  v_and_b32 v53, s55, v78
  v_lshlrev_b32 v54, 16, v79
  v_and_b32_e64 v55, s55, v79
  v_pk_fma_f32 v[48:49], v[48:49], v[42:43], v[44:45]
  v_pk_fma_f32 v[50:51], v[50:51], v[42:43], v[44:45]
  v_pk_fma_f32 v[52:53], v[52:53], v[42:43], v[44:45]
  v_pk_fma_f32 v[54:55], v[54:55], v[42:43], v[44:45]
  v_cvt_pk_bf16_f32 v76, v48, v49
  v_cvt_pk_bf16_f32 v77, v50, v51
  v_cvt_pk_bf16_f32 v78, v52, v53
  v_cvt_pk_bf16_f32 v79, v54, v55
  ds_write_b128 v14, v[76:79] offset:5120
  s_waitcnt vmcnt(1)
  v_lshlrev_b32 v48, 16, v80
  v_and_b32 v49, s55, v80
  v_lshlrev_b32 v50, 16, v81
  v_and_b32 v51, s55, v81
  v_lshlrev_b32 v52, 16, v82
  v_and_b32 v53, s55, v82
  v_lshlrev_b32 v54, 16, v83
  v_and_b32_e64 v55, s55, v83
  v_pk_fma_f32 v[48:49], v[48:49], v[42:43], v[44:45]
  v_pk_fma_f32 v[50:51], v[50:51], v[42:43], v[44:45]
  v_pk_fma_f32 v[52:53], v[52:53], v[42:43], v[44:45]
  v_pk_fma_f32 v[54:55], v[54:55], v[42:43], v[44:45]
  v_cvt_pk_bf16_f32 v80, v48, v49
  v_cvt_pk_bf16_f32 v81, v50, v51
  v_cvt_pk_bf16_f32 v82, v52, v53
  v_cvt_pk_bf16_f32 v83, v54, v55
  ds_write_b128 v14, v[80:83] offset:6144
  s_waitcnt vmcnt(0)
  v_lshlrev_b32 v48, 16, v84
  v_and_b32 v49, s55, v84
  v_lshlrev_b32 v50, 16, v85
  v_and_b32 v51, s55, v85
  v_lshlrev_b32 v52, 16, v86
  v_and_b32 v53, s55, v86
  v_lshlrev_b32 v54, 16, v87
  v_and_b32_e64 v55, s55, v87
  v_pk_fma_f32 v[48:49], v[48:49], v[42:43], v[44:45]
  v_pk_fma_f32 v[50:51], v[50:51], v[42:43], v[44:45]
  v_pk_fma_f32 v[52:53], v[52:53], v[42:43], v[44:45]
  v_pk_fma_f32 v[54:55], v[54:55], v[42:43], v[44:45]
  v_cvt_pk_bf16_f32 v84, v48, v49
  v_cvt_pk_bf16_f32 v85, v50, v51
  v_cvt_pk_bf16_f32 v86, v52, v53
  v_cvt_pk_bf16_f32 v87, v54, v55
  ds_write_b128 v14, v[84:87] offset:7168
  s_waitcnt vmcnt(0)
  s_waitcnt lgkmcnt(0)
  s_barrier
  ds_read_b128 v[56:59], v10 offset:0
  ds_read_b64_tr_b16 v[64:65], v8 offset:0
  ds_read_b64_tr_b16 v[66:67], v8 offset:2048
  ds_read_b128 v[60:63], v10 offset:16384
  ds_read_b64_tr_b16 v[68:69], v8 offset:8192
  ds_read_b64_tr_b16 v[70:71], v8 offset:10240
  ds_read_b64_tr_b16 v[72:73], v8 offset:16384
  ds_read_b64_tr_b16 v[74:75], v8 offset:18432
  ds_read_b128 v[76:79], v10 offset:1024
  ds_read_b64_tr_b16 v[84:85], v8 offset:4096
  ds_read_b64_tr_b16 v[86:87], v8 offset:6144
  ds_read_b128 v[80:83], v10 offset:17408
  ds_read_b64_tr_b16 v[88:89], v8 offset:12288
  ds_read_b64_tr_b16 v[90:91], v8 offset:14336
  ds_read_b64_tr_b16 v[92:93], v8 offset:20480
  ds_read_b64_tr_b16 v[94:95], v8 offset:22528
  s_barrier
  s_waitcnt lgkmcnt(8)
  v_mfma_f32_16x16x32_bf16 v[16:19], v[64:67], v[56:59], 0
  ds_read_b128 v[96:99], v10 offset:2048
  s_cmp_ge_u32 s46, 4
  s_cbranch_scc1 L_ho_46
  s_lshl_b32 s97, s48, 1
  s_add_u32 s97, s97, 3
  s_and_b32 s97, s97, 7
  s_mul_i32 s97, s97, 176128
  s_add_u32 s97, s97, s93
  s_add_u32 m0, s56, 139264
  s_nop 0
  buffer_load_dwordx4 v244, s[16:19], s97 offen lds
  s_sub_u32 s97, s97, s93
  s_add_u32 s97, s97, s92
  s_add_u32 m0, s56, 147456
  s_nop 0
  buffer_load_dwordx4 v244, s[16:19], s97 offen lds
  s_sub_u32 s97, s97, s92
  s_add_u32 m0, s56, 155648
  s_nop 0
  buffer_load_dwordx4 v245, s[16:19], s97 offen lds
L_ho_46:
  v_mfma_f32_16x16x32_bf16 v[20:23], v[64:67], v[60:63], 0
  ds_read_b64_tr_b16 v[104:105], v8 offset:24576
  v_mfma_f32_16x16x32_bf16 v[24:27], v[68:71], v[56:59], 0
  ds_read_b64_tr_b16 v[106:107], v8 offset:26624
  ds_read_b128 v[100:103], v10 offset:18432
  v_mfma_f32_16x16x32_bf16 v[28:31], v[68:71], v[60:63], 0
  ds_read_b64_tr_b16 v[108:109], v8 offset:32768
  v_mfma_f32_16x16x32_bf16 v[32:35], v[72:75], v[56:59], 0
  ds_read_b64_tr_b16 v[110:111], v8 offset:34816
  ds_read_b64_tr_b16 v[112:113], v8 offset:40960
  v_mfma_f32_16x16x32_bf16 v[36:39], v[72:75], v[60:63], 0
  ds_read_b64_tr_b16 v[114:115], v8 offset:43008
  s_waitcnt lgkmcnt(8)
  v_mfma_f32_16x16x32_bf16 v[16:19], v[84:87], v[76:79], v[16:19]
  ds_read_b128 v[56:59], v10 offset:3072
  s_cmp_lt_u32 s46, 4
  s_cbranch_scc1 L_ho_47
  s_lshl_b32 s97, s48, 1
  s_add_u32 s97, s97, 3
  s_and_b32 s97, s97, 7
  s_mul_i32 s97, s97, 176128
  s_add_u32 s97, s97, s93
  s_add_u32 m0, s56, 139264
  s_nop 0
  buffer_load_dwordx4 v244, s[16:19], s97 offen lds
  s_sub_u32 s97, s97, s93
  s_add_u32 s97, s97, s92
  s_add_u32 m0, s56, 147456
  s_nop 0
  buffer_load_dwordx4 v244, s[16:19], s97 offen lds
  s_sub_u32 s97, s97, s92
  s_add_u32 m0, s56, 155648
  s_nop 0
  buffer_load_dwordx4 v245, s[16:19], s97 offen lds
L_ho_47:
  v_mfma_f32_16x16x32_bf16 v[20:23], v[84:87], v[80:83], v[20:23]
  ds_read_b64_tr_b16 v[64:65], v8 offset:28672
  v_mfma_f32_16x16x32_bf16 v[24:27], v[88:91], v[76:79], v[24:27]
  ds_read_b64_tr_b16 v[66:67], v8 offset:30720
  ds_read_b128 v[60:63], v10 offset:19456
  v_mfma_f32_16x16x32_bf16 v[28:31], v[88:91], v[80:83], v[28:31]
  ds_read_b64_tr_b16 v[68:69], v8 offset:36864
  v_mfma_f32_16x16x32_bf16 v[32:35], v[92:95], v[76:79], v[32:35]
  ds_read_b64_tr_b16 v[70:71], v8 offset:38912
  ds_read_b64_tr_b16 v[72:73], v8 offset:45056
  v_mfma_f32_16x16x32_bf16 v[36:39], v[92:95], v[80:83], v[36:39]
  ds_read_b64_tr_b16 v[74:75], v8 offset:47104
  s_barrier
  s_waitcnt lgkmcnt(8)
  v_mfma_f32_16x16x32_bf16 v[16:19], v[104:107], v[96:99], v[16:19]
  ds_read_b128 v[76:79], v10 offset:4096
  s_cmp_ge_u32 s46, 4
  s_cbranch_scc1 L_ho_48
  s_lshl_b32 s97, s48, 1
  s_add_u32 s97, s97, 4
  s_and_b32 s97, s97, 7
  s_mul_i32 s97, s97, 176128
  s_add_u32 s97, s97, s93
  s_add_u32 m0, s56, 65536
  s_nop 0
  buffer_load_dwordx4 v244, s[16:19], s97 offen lds
  s_sub_u32 s97, s97, s93
  s_add_u32 s97, s97, s92
  s_add_u32 m0, s56, 73728
  s_nop 0
  buffer_load_dwordx4 v244, s[16:19], s97 offen lds
  s_sub_u32 s97, s97, s92
  s_add_u32 m0, s56, 81920
  s_nop 0
  buffer_load_dwordx4 v245, s[16:19], s97 offen lds
L_ho_48:
  ds_read_b64_tr_b16 v[84:85], v9 offset:0
  v_mfma_f32_16x16x32_bf16 v[20:23], v[104:107], v[100:103], v[20:23]
  ds_read_b64_tr_b16 v[86:87], v9 offset:2048
  ds_read_b128 v[80:83], v10 offset:20480
  v_mfma_f32_16x16x32_bf16 v[24:27], v[108:111], v[96:99], v[24:27]
  ds_read_b64_tr_b16 v[88:89], v9 offset:8192
  ds_read_b64_tr_b16 v[90:91], v9 offset:10240
  v_mfma_f32_16x16x32_bf16 v[28:31], v[108:111], v[100:103], v[28:31]
  ds_read_b64_tr_b16 v[92:93], v9 offset:16384
  ds_read_b64_tr_b16 v[94:95], v9 offset:18432
  v_mfma_f32_16x16x32_bf16 v[32:35], v[112:115], v[96:99], v[32:35]
  v_mov_b32 v48, 0xc0135761
  v_mov_b32 v49, 0xc0135761
  v_mov_b32 v50, 0xbdd2d3e8
  v_mov_b32 v51, 0xbdd2d3e8
  v_mfma_f32_16x16x32_bf16 v[36:39], v[112:115], v[100:103], v[36:39]
  v_mov_b32 v52, 0x3f800000
  v_mov_b32 v53, 0x3f800000
  v_and_b32 v5, 31, v1
  v_lshrrev_b32_e64 v6, 5, v1
  s_waitcnt lgkmcnt(8)
  v_mfma_f32_16x16x32_bf16 v[16:19], v[64:67], v[56:59], v[16:19]
  ds_read_b128 v[96:99], v10 offset:5120
  s_cmp_lt_u32 s46, 4
  s_cbranch_scc1 L_ho_49
  s_lshl_b32 s97, s48, 1
  s_add_u32 s97, s97, 4
  s_and_b32 s97, s97, 7
  s_mul_i32 s97, s97, 176128
  s_add_u32 s97, s97, s93
  s_add_u32 m0, s56, 65536
  s_nop 0
  buffer_load_dwordx4 v244, s[16:19], s97 offen lds
  s_sub_u32 s97, s97, s93
  s_add_u32 s97, s97, s92
  s_add_u32 m0, s56, 73728
  s_nop 0
  buffer_load_dwordx4 v244, s[16:19], s97 offen lds
  s_sub_u32 s97, s97, s92
  s_add_u32 m0, s56, 81920
  s_nop 0
  buffer_load_dwordx4 v245, s[16:19], s97 offen lds
L_ho_49:
  ds_read_b64_tr_b16 v[104:105], v9 offset:4096
  v_mfma_f32_16x16x32_bf16 v[20:23], v[64:67], v[60:63], v[20:23]
  ds_read_b64_tr_b16 v[106:107], v9 offset:6144
  ds_read_b128 v[100:103], v10 offset:21504
  v_mfma_f32_16x16x32_bf16 v[24:27], v[68:71], v[56:59], v[24:27]
  ds_read_b64_tr_b16 v[108:109], v9 offset:12288
  ds_read_b64_tr_b16 v[110:111], v9 offset:14336
  v_mfma_f32_16x16x32_bf16 v[28:31], v[68:71], v[60:63], v[28:31]
  ds_read_b64_tr_b16 v[112:113], v9 offset:20480
  ds_read_b64_tr_b16 v[114:115], v9 offset:22528
  v_mfma_f32_16x16x32_bf16 v[32:35], v[72:75], v[56:59], v[32:35]
  v_bfe_u32 v7, v5, 1, 3
  v_xor_b32 v6, v6, v7
  v_lshlrev_b32 v6, 4, v6
  v_lshl_add_u32 v6, v5, 7, v6
  v_mfma_f32_16x16x32_bf16 v[36:39], v[72:75], v[60:63], v[36:39]
  v_add_u32 v40, s58, v6
  v_xor_b32 v41, 32, v40
  v_xor_b32_e64 v42, 64, v40
  v_xor_b32 v43, 96, v40
  s_waitcnt vmcnt(3)
  s_barrier
  s_waitcnt lgkmcnt(8)
  v_mfma_f32_16x16x32_bf16 v[16:19], v[84:87], v[76:79], v[16:19]
  ds_read_b128 v[56:59], v10 offset:6144
  s_cmp_ge_u32 s46, 4
  s_cbranch_scc1 L_ho_50
  s_lshl_b32 s97, s48, 1
  s_add_u32 s97, s97, 5
  s_and_b32 s97, s97, 7
  s_mul_i32 s97, s97, 176128
  s_add_u32 s97, s97, s93
  s_add_u32 m0, s56, 90112
  s_nop 0
  buffer_load_dwordx4 v244, s[16:19], s97 offen lds
  s_sub_u32 s97, s97, s93
  s_add_u32 s97, s97, s92
  s_add_u32 m0, s56, 98304
  s_nop 0
  buffer_load_dwordx4 v244, s[16:19], s97 offen lds
  s_sub_u32 s97, s97, s92
  s_add_u32 m0, s56, 106496
  s_nop 0
  buffer_load_dwordx4 v245, s[16:19], s97 offen lds
L_ho_50:
  ds_read_b64_tr_b16 v[64:65], v9 offset:24576
  v_mfma_f32_16x16x32_bf16 v[20:23], v[84:87], v[80:83], v[20:23]
  ds_read_b64_tr_b16 v[66:67], v9 offset:26624
  ds_read_b128 v[60:63], v10 offset:22528
  v_mfma_f32_16x16x32_bf16 v[24:27], v[88:91], v[76:79], v[24:27]
  ds_read_b64_tr_b16 v[68:69], v9 offset:32768
  ds_read_b64_tr_b16 v[70:71], v9 offset:34816
  v_mfma_f32_16x16x32_bf16 v[28:31], v[88:91], v[80:83], v[28:31]
  ds_read_b64_tr_b16 v[72:73], v9 offset:40960
  ds_read_b64_tr_b16 v[74:75], v9 offset:43008
  v_mfma_f32_16x16x32_bf16 v[32:35], v[92:95], v[76:79], v[32:35]
  s_cmp_eq_u32 s59, 1
  s_cselect_b32 s72, s53, 0
  s_cmp_eq_u32 s59, 0
  s_cselect_b32 s72, 1, s72
  s_mul_i32 s72, s72, 0x3f800000
  s_mov_b32 s73, s72
  v_mfma_f32_16x16x32_bf16 v[36:39], v[92:95], v[80:83], v[36:39]
  v_and_b32 v5, 15, v1
  v_lshrrev_b32_e64 v6, 5, v1
  v_lshl_add_u32 v5, v6, 4, v5
  v_lshlrev_b32 v5, 3, v5
  s_waitcnt lgkmcnt(8)
  v_mfma_f32_16x16x32_bf16 v[16:19], v[104:107], v[96:99], v[16:19]
  ds_read_b128 v[76:79], v10 offset:7168
  s_cmp_lt_u32 s46, 4
  s_cbranch_scc1 L_ho_51
  s_lshl_b32 s97, s48, 1
  s_add_u32 s97, s97, 5
  s_and_b32 s97, s97, 7
  s_mul_i32 s97, s97, 176128
  s_add_u32 s97, s97, s93
  s_add_u32 m0, s56, 90112
  s_nop 0
  buffer_load_dwordx4 v244, s[16:19], s97 offen lds
  s_sub_u32 s97, s97, s93
  s_add_u32 s97, s97, s92
  s_add_u32 m0, s56, 98304
  s_nop 0
  buffer_load_dwordx4 v244, s[16:19], s97 offen lds
  s_sub_u32 s97, s97, s92
  s_add_u32 m0, s56, 106496
  s_nop 0
  buffer_load_dwordx4 v245, s[16:19], s97 offen lds
L_ho_51:
  ds_read_b64_tr_b16 v[84:85], v9 offset:28672
  v_mfma_f32_16x16x32_bf16 v[20:23], v[104:107], v[100:103], v[20:23]
  ds_read_b64_tr_b16 v[86:87], v9 offset:30720
  ds_read_b128 v[80:83], v10 offset:23552
  v_mfma_f32_16x16x32_bf16 v[24:27], v[108:111], v[96:99], v[24:27]
  ds_read_b64_tr_b16 v[88:89], v9 offset:36864
  ds_read_b64_tr_b16 v[90:91], v9 offset:38912
  v_mfma_f32_16x16x32_bf16 v[28:31], v[108:111], v[100:103], v[28:31]
  ds_read_b64_tr_b16 v[92:93], v9 offset:45056
  ds_read_b64_tr_b16 v[94:95], v9 offset:47104
  v_mfma_f32_16x16x32_bf16 v[32:35], v[112:115], v[96:99], v[32:35]
  v_bfe_u32 v7, v1, 4, 1
  v_lshl_add_u32 v5, v7, 2, v5
  s_lshl_b32 s65, s59, 9
  s_and_b32 s66, s46, 1
  v_mfma_f32_16x16x32_bf16 v[36:39], v[112:115], v[100:103], v[36:39]
  s_lshl_b32 s67, s66, 8
  s_add_u32 s65, s65, s67
  s_add_u32 s65, s65, 98304
  v_add_u32 v14, s65, v5
  s_waitcnt vmcnt(3)
  s_barrier
  s_waitcnt lgkmcnt(8)
  v_mfma_f32_16x16x32_bf16 v[16:19], v[64:67], v[56:59], v[16:19]
  ds_read_b128 v[96:99], v10 offset:8192
  s_cmp_ge_u32 s46, 4
  s_cbranch_scc1 L_ho_52
  s_lshl_b32 s97, s48, 1
  s_add_u32 s97, s97, 6
  s_and_b32 s97, s97, 7
  s_mul_i32 s97, s97, 176128
  s_add_u32 s97, s97, s93
  s_add_u32 m0, s56, 114688
  s_nop 0
  buffer_load_dwordx4 v244, s[16:19], s97 offen lds
  s_sub_u32 s97, s97, s93
  s_add_u32 s97, s97, s92
  s_add_u32 m0, s56, 122880
  s_nop 0
  buffer_load_dwordx4 v244, s[16:19], s97 offen lds
  s_sub_u32 s97, s97, s92
  s_add_u32 m0, s56, 131072
  s_nop 0
  buffer_load_dwordx4 v245, s[16:19], s97 offen lds
L_ho_52:
  ds_read_b64_tr_b16 v[104:105], v8 offset:0
  v_mfma_f32_16x16x32_bf16 v[20:23], v[64:67], v[60:63], v[20:23]
  ds_read_b64_tr_b16 v[106:107], v8 offset:2048
  ds_read_b128 v[100:103], v10 offset:24576
  v_mfma_f32_16x16x32_bf16 v[24:27], v[68:71], v[56:59], v[24:27]
  ds_read_b64_tr_b16 v[108:109], v8 offset:8192
  ds_read_b64_tr_b16 v[110:111], v8 offset:10240
  v_mfma_f32_16x16x32_bf16 v[28:31], v[68:71], v[60:63], v[28:31]
  ds_read_b64_tr_b16 v[112:113], v8 offset:16384
  ds_read_b64_tr_b16 v[114:115], v8 offset:18432
  v_mfma_f32_16x16x32_bf16 v[32:35], v[72:75], v[56:59], v[32:35]
  s_lshl_b32 s63, s48, 13
  s_add_u32 s63, s63, s101
  s_add_u32 s63, s63, 819200
  s_lshl_b32 s64, s49, 10
  v_mfma_f32_16x16x32_bf16 v[36:39], v[72:75], v[60:63], v[36:39]
  s_add_u32 s64, s64, s63
  s_lshl_b32 s66, s66, 9
  s_add_u32 s63, s63, s66
  v_lshlrev_b32 v55, 3, v1
  s_waitcnt lgkmcnt(8)
  v_mfma_f32_16x16x32_bf16 v[16:19], v[84:87], v[76:79], v[16:19]
  ds_read_b128 v[56:59], v10 offset:9216
  s_cmp_lt_u32 s46, 4
  s_cbranch_scc1 L_ho_53
  s_lshl_b32 s97, s48, 1
  s_add_u32 s97, s97, 6
  s_and_b32 s97, s97, 7
  s_mul_i32 s97, s97, 176128
  s_add_u32 s97, s97, s93
  s_add_u32 m0, s56, 114688
  s_nop 0
  buffer_load_dwordx4 v244, s[16:19], s97 offen lds
  s_sub_u32 s97, s97, s93
  s_add_u32 s97, s97, s92
  s_add_u32 m0, s56, 122880
  s_nop 0
  buffer_load_dwordx4 v244, s[16:19], s97 offen lds
  s_sub_u32 s97, s97, s92
  s_add_u32 m0, s56, 131072
  s_nop 0
  buffer_load_dwordx4 v245, s[16:19], s97 offen lds
L_ho_53:
  ds_read_b64_tr_b16 v[64:65], v8 offset:4096
  v_mfma_f32_16x16x32_bf16 v[20:23], v[84:87], v[80:83], v[20:23]
  ds_read_b64_tr_b16 v[66:67], v8 offset:6144
  ds_read_b128 v[60:63], v10 offset:25600
  v_mfma_f32_16x16x32_bf16 v[24:27], v[88:91], v[76:79], v[24:27]
  ds_read_b64_tr_b16 v[68:69], v8 offset:12288
  ds_read_b64_tr_b16 v[70:71], v8 offset:14336
  v_mfma_f32_16x16x32_bf16 v[28:31], v[88:91], v[80:83], v[28:31]
  ds_read_b64_tr_b16 v[72:73], v8 offset:20480
  ds_read_b64_tr_b16 v[74:75], v8 offset:22528
  v_mfma_f32_16x16x32_bf16 v[32:35], v[92:95], v[76:79], v[32:35]
  v_add_u32 v44, 98304, v55
  v_and_b32 v5, 31, v1
  v_lshlrev_b32 v5, 4, v5
  v_lshl_add_u32 v45, v6, 12, v5
  v_mfma_f32_16x16x32_bf16 v[36:39], v[92:95], v[80:83], v[36:39]
  s_cmp_lt_u32 s59, 2
  s_cselect_b32 s66, 1.0, 0
  s_cselect_b32 s67, 0, 1.0
  s_cselect_b32 s68, 13312, 0
  s_cselect_b32 s70, 0, 1
  s_cmp_eq_u32 s72, 0
  s_cselect_b32 s66, 0, s66
  s_and_b32 s71, s52, 1
  s_xor_b32 s70, s70, s71
  s_waitcnt vmcnt(3)
  s_barrier
  s_waitcnt lgkmcnt(8)
  v_mfma_f32_16x16x32_bf16 v[16:19], v[104:107], v[96:99], v[16:19]
  ds_read_b128 v[76:79], v10 offset:10240
  s_cmp_ge_u32 s46, 4
  s_cbranch_scc1 L_ho_54
  s_lshl_b32 s97, s48, 1
  s_add_u32 s97, s97, 7
  s_and_b32 s97, s97, 7
  s_mul_i32 s97, s97, 176128
  s_add_u32 s97, s97, s93
  s_add_u32 m0, s56, 139264
  s_nop 0
  buffer_load_dwordx4 v244, s[16:19], s97 offen lds
  s_sub_u32 s97, s97, s93
  s_add_u32 s97, s97, s92
  s_add_u32 m0, s56, 147456
  s_nop 0
  buffer_load_dwordx4 v244, s[16:19], s97 offen lds
  s_sub_u32 s97, s97, s92
  s_add_u32 m0, s56, 155648
  s_nop 0
  buffer_load_dwordx4 v245, s[16:19], s97 offen lds
L_ho_54:
  ds_read_b64_tr_b16 v[84:85], v8 offset:24576
  v_mfma_f32_16x16x32_bf16 v[20:23], v[104:107], v[100:103], v[20:23]
  ds_read_b64_tr_b16 v[86:87], v8 offset:26624
  ds_read_b128 v[80:83], v10 offset:26624
  v_mfma_f32_16x16x32_bf16 v[24:27], v[108:111], v[96:99], v[24:27]
  ds_read_b64_tr_b16 v[88:89], v8 offset:32768
  ds_read_b64_tr_b16 v[90:91], v8 offset:34816
  v_mfma_f32_16x16x32_bf16 v[28:31], v[108:111], v[100:103], v[28:31]
  ds_read_b64_tr_b16 v[92:93], v8 offset:40960
  ds_read_b64_tr_b16 v[94:95], v8 offset:43008
  v_mfma_f32_16x16x32_bf16 v[32:35], v[112:115], v[96:99], v[32:35]
  s_and_b32 s74, s59, 1
  s_or_b32 s75, s70, s74
  s_cmp_eq_u32 s75, 0
  s_cselect_b32 s75, 0, 128
  s_lshl_b32 s74, s74, 5
  v_mfma_f32_16x16x32_bf16 v[36:39], v[112:115], v[100:103], v[36:39]
  s_add_u32 s75, s75, s74
  s_add_u32 s68, s68, s75
  v_add_u32 v15, s68, v13
  s_lshl_b32 s68, s59, 5
  s_waitcnt lgkmcnt(8)
  v_mfma_f32_16x16x32_bf16 v[16:19], v[64:67], v[56:59], v[16:19]
  ds_read_b128 v[96:99], v10 offset:11264
  s_cmp_lt_u32 s46, 4
  s_cbranch_scc1 L_ho_55
  s_lshl_b32 s97, s48, 1
  s_add_u32 s97, s97, 7
  s_and_b32 s97, s97, 7
  s_mul_i32 s97, s97, 176128
  s_add_u32 s97, s97, s93
  s_add_u32 m0, s56, 139264
  s_nop 0
  buffer_load_dwordx4 v244, s[16:19], s97 offen lds
  s_sub_u32 s97, s97, s93
  s_add_u32 s97, s97, s92
  s_add_u32 m0, s56, 147456
  s_nop 0
  buffer_load_dwordx4 v244, s[16:19], s97 offen lds
  s_sub_u32 s97, s97, s92
  s_add_u32 m0, s56, 155648
  s_nop 0
  buffer_load_dwordx4 v245, s[16:19], s97 offen lds
L_ho_55:
  ds_read_b64_tr_b16 v[104:105], v8 offset:28672
  v_mfma_f32_16x16x32_bf16 v[20:23], v[64:67], v[60:63], v[20:23]
  ds_read_b64_tr_b16 v[106:107], v8 offset:30720
  ds_read_b128 v[100:103], v10 offset:27648
  v_mfma_f32_16x16x32_bf16 v[24:27], v[68:71], v[56:59], v[24:27]
  ds_read_b64_tr_b16 v[108:109], v8 offset:36864
  ds_read_b64_tr_b16 v[110:111], v8 offset:38912
  v_mfma_f32_16x16x32_bf16 v[28:31], v[68:71], v[60:63], v[28:31]
  ds_read_b64_tr_b16 v[112:113], v8 offset:45056
  ds_read_b64_tr_b16 v[114:115], v8 offset:47104
  v_mfma_f32_16x16x32_bf16 v[32:35], v[72:75], v[56:59], v[32:35]
  s_lshl_b32 s71, s71, 5
  s_add_u32 s74, s68, s71
  s_sub_u32 s68, s68, s71
  s_add_u32 s68, s68, 32
  v_mfma_f32_16x16x32_bf16 v[36:39], v[72:75], v[60:63], v[36:39]
  v_add_u32 v7, s68, v13
  v_add_u32 v13, s74, v13
  s_mul_i32 s68, s46, 1536
  v_add_u32 v54, s68, v4
  s_waitcnt vmcnt(3)
  s_barrier
  s_waitcnt lgkmcnt(8)
  v_mfma_f32_16x16x32_bf16 v[16:19], v[84:87], v[76:79], v[16:19]
  ds_read_b128 v[56:59], v10 offset:12288
  ds_read_b64_tr_b16 v[64:65], v9 offset:0
  v_mfma_f32_16x16x32_bf16 v[20:23], v[84:87], v[80:83], v[20:23]
  ds_read_b64_tr_b16 v[66:67], v9 offset:2048
  ds_read_b128 v[60:63], v10 offset:28672
  v_mfma_f32_16x16x32_bf16 v[24:27], v[88:91], v[76:79], v[24:27]
  ds_read_b64_tr_b16 v[68:69], v9 offset:8192
  ds_read_b64_tr_b16 v[70:71], v9 offset:10240
  v_mfma_f32_16x16x32_bf16 v[28:31], v[88:91], v[80:83], v[28:31]
  ds_read_b64_tr_b16 v[72:73], v9 offset:16384
  ds_read_b64_tr_b16 v[74:75], v9 offset:18432
  v_mfma_f32_16x16x32_bf16 v[32:35], v[92:95], v[76:79], v[32:35]
  v_add_u32 v47, 1024, v55
  v_add_u32_e64 v55, s68, v55
  s_mul_i32 s68, s46, 1664
  v_mul_u32_u24 v46, 5462, v1
  v_mfma_f32_16x16x32_bf16 v[36:39], v[92:95], v[80:83], v[36:39]
  v_lshrrev_b32_e64 v46, 16, v46
  v_lshl_add_u32 v46, v46, 4, v4
  v_add_u32_e64 v46, s68, v46
  v_mul_u32_u24 v5, 21846, v47
  s_waitcnt lgkmcnt(8)
  v_mfma_f32_16x16x32_bf16 v[16:19], v[104:107], v[96:99], v[16:19]
  ds_read_b128 v[76:79], v10 offset:13312
  ds_read_b64_tr_b16 v[84:85], v9 offset:4096
  v_mfma_f32_16x16x32_bf16 v[20:23], v[104:107], v[100:103], v[20:23]
  ds_read_b64_tr_b16 v[86:87], v9 offset:6144
  ds_read_b128 v[80:83], v10 offset:29696
  v_mfma_f32_16x16x32_bf16 v[24:27], v[108:111], v[96:99], v[24:27]
  ds_read_b64_tr_b16 v[88:89], v9 offset:12288
  ds_read_b64_tr_b16 v[90:91], v9 offset:14336
  v_mfma_f32_16x16x32_bf16 v[28:31], v[108:111], v[100:103], v[28:31]
  ds_read_b64_tr_b16 v[92:93], v9 offset:20480
  ds_read_b64_tr_b16 v[94:95], v9 offset:22528
  v_mfma_f32_16x16x32_bf16 v[32:35], v[112:115], v[96:99], v[32:35]
  v_lshrrev_b32 v5, 22, v5
  v_lshl_add_u32 v47, v5, 4, v47
  v_add_u32_e64 v47, s68, v47
  s_mul_i32 s69, s49, 393216
  v_mfma_f32_16x16x32_bf16 v[36:39], v[112:115], v[100:103], v[36:39]
  s_mul_i32 s68, s50, 12288
  s_add_u32 s69, s69, s68
  s_add_u32 s69, s69, 4194304
  s_waitcnt vmcnt(0)
  s_barrier
  s_waitcnt lgkmcnt(8)
  v_mfma_f32_16x16x32_bf16 v[16:19], v[64:67], v[56:59], v[16:19]
  ds_read_b128 v[96:99], v10 offset:14336
  ds_read_b64_tr_b16 v[104:105], v9 offset:24576
  v_mfma_f32_16x16x32_bf16 v[20:23], v[64:67], v[60:63], v[20:23]
  ds_read_b64_tr_b16 v[106:107], v9 offset:26624
  v_mfma_f32_16x16x32_bf16 v[24:27], v[68:71], v[56:59], v[24:27]
  ds_read_b128 v[100:103], v10 offset:30720
  ds_read_b64_tr_b16 v[108:109], v9 offset:32768
  v_mfma_f32_16x16x32_bf16 v[28:31], v[68:71], v[60:63], v[28:31]
  ds_read_b64_tr_b16 v[110:111], v9 offset:34816
  v_mfma_f32_16x16x32_bf16 v[32:35], v[72:75], v[56:59], v[32:35]
  ds_read_b64_tr_b16 v[112:113], v9 offset:40960
  ds_read_b64_tr_b16 v[114:115], v9 offset:43008
  v_mfma_f32_16x16x32_bf16 v[36:39], v[72:75], v[60:63], v[36:39]
  s_add_u32 s62, s57, 384
  s_add_u32 m0, s58, 0
  s_nop 0
  buffer_load_dwordx4 v11, s[20:23], s62 offen lds
  s_waitcnt lgkmcnt(8)
  v_mfma_f32_16x16x32_bf16 v[16:19], v[84:87], v[76:79], v[16:19]
  ds_read_b128 v[56:59], v10 offset:15360
  ds_read_b64_tr_b16 v[64:65], v9 offset:28672
  v_mfma_f32_16x16x32_bf16 v[20:23], v[84:87], v[80:83], v[20:23]
  ds_read_b64_tr_b16 v[66:67], v9 offset:30720
  v_mfma_f32_16x16x32_bf16 v[24:27], v[88:91], v[76:79], v[24:27]
  ds_read_b128 v[60:63], v10 offset:31744
  ds_read_b64_tr_b16 v[68:69], v9 offset:36864
  v_mfma_f32_16x16x32_bf16 v[28:31], v[88:91], v[80:83], v[28:31]
  ds_read_b64_tr_b16 v[70:71], v9 offset:38912
  v_mfma_f32_16x16x32_bf16 v[32:35], v[92:95], v[76:79], v[32:35]
  ds_read_b64_tr_b16 v[72:73], v9 offset:45056
  ds_read_b64_tr_b16 v[74:75], v9 offset:47104
  v_mfma_f32_16x16x32_bf16 v[36:39], v[92:95], v[80:83], v[36:39]
  s_add_u32 s62, s62, 32768
  s_add_u32 m0, s58, 1024
  s_nop 0
  buffer_load_dwordx4 v12, s[20:23], s62 offen lds
  s_waitcnt lgkmcnt(8)
  v_mfma_f32_16x16x32_bf16 v[16:19], v[104:107], v[96:99], v[16:19]
  s_add_u32 s62, s62, 32768
  s_add_u32 m0, s58, 2048
  s_nop 0
  buffer_load_dwordx4 v11, s[20:23], s62 offen lds
  v_mfma_f32_16x16x32_bf16 v[20:23], v[104:107], v[100:103], v[20:23]
  v_mfma_f32_16x16x32_bf16 v[24:27], v[108:111], v[96:99], v[24:27]
  v_mfma_f32_16x16x32_bf16 v[28:31], v[108:111], v[100:103], v[28:31]
  v_mfma_f32_16x16x32_bf16 v[32:35], v[112:115], v[96:99], v[32:35]
  v_mfma_f32_16x16x32_bf16 v[36:39], v[112:115], v[100:103], v[36:39]
  s_waitcnt lgkmcnt(0)
  v_mfma_f32_16x16x32_bf16 v[16:19], v[64:67], v[56:59], v[16:19]
  s_add_u32 s62, s62, 32768
  s_add_u32 m0, s58, 3072
  s_nop 0
  buffer_load_dwordx4 v12, s[20:23], s62 offen lds
  v_mfma_f32_16x16x32_bf16 v[20:23], v[64:67], v[60:63], v[20:23]
  v_mfma_f32_16x16x32_bf16 v[24:27], v[68:71], v[56:59], v[24:27]
  v_mfma_f32_16x16x32_bf16 v[28:31], v[68:71], v[60:63], v[28:31]
  v_mfma_f32_16x16x32_bf16 v[32:35], v[72:75], v[56:59], v[32:35]
  v_mfma_f32_16x16x32_bf16 v[36:39], v[72:75], v[60:63], v[36:39]
  v_pk_mul_f32 v[56:57], v[16:17], v[16:17]
  v_pk_mul_f32 v[58:59], v[18:19], v[18:19]
  s_nop 1
  v_pk_mul_f32 v[60:61], v[20:21], v[20:21]
  v_pk_mul_f32 v[62:63], v[22:23], v[22:23]
  v_pk_fma_f32 v[56:57], v[56:57], v[50:51], v[48:49]
  v_pk_fma_f32 v[58:59], v[58:59], v[50:51], v[48:49]
  v_pk_fma_f32 v[60:61], v[60:61], v[50:51], v[48:49]
  v_pk_fma_f32 v[62:63], v[62:63], v[50:51], v[48:49]
  v_pk_mul_f32 v[56:57], v[56:57], v[16:17]
  v_pk_mul_f32 v[58:59], v[58:59], v[18:19]
  v_pk_mul_f32 v[60:61], v[60:61], v[20:21]
  v_pk_mul_f32 v[62:63], v[62:63], v[22:23]
  v_exp_f32 v56, v56
  v_exp_f32 v57, v57
  v_exp_f32 v58, v58
  v_exp_f32 v59, v59
  v_exp_f32 v60, v60
  v_exp_f32 v61, v61
  v_exp_f32 v62, v62
  v_exp_f32_e64 v63, v63
  v_pk_add_f32 v[56:57], v[56:57], v[52:53]
  v_pk_add_f32 v[58:59], v[58:59], v[52:53]
  v_pk_add_f32 v[60:61], v[60:61], v[52:53]
  v_pk_add_f32 v[62:63], v[62:63], v[52:53]
  v_rcp_f32 v56, v56
  v_rcp_f32 v57, v57
  v_rcp_f32 v58, v58
  v_rcp_f32 v59, v59
  v_rcp_f32 v60, v60
  v_rcp_f32 v61, v61
  v_rcp_f32 v62, v62
  v_rcp_f32 v63, v63
  v_pk_mul_f32 v[16:17], v[16:17], v[56:57]
  v_pk_mul_f32 v[18:19], v[18:19], v[58:59]
  v_pk_mul_f32 v[20:21], v[20:21], v[60:61]
  v_pk_mul_f32 v[22:23], v[22:23], v[62:63]
  s_cmp_ge_u32 s46, 4
  s_cbranch_scc1 L_hi_56
  v_pk_mul_f32 v[56:57], v[32:33], v[32:33]
  v_pk_mul_f32 v[58:59], v[34:35], v[34:35]
  v_pk_mul_f32 v[60:61], v[36:37], v[36:37]
  v_pk_mul_f32 v[62:63], v[38:39], v[38:39]
  v_pk_fma_f32 v[56:57], v[56:57], v[50:51], v[48:49]
  v_pk_fma_f32 v[58:59], v[58:59], v[50:51], v[48:49]
  v_pk_fma_f32 v[60:61], v[60:61], v[50:51], v[48:49]
  v_pk_fma_f32 v[62:63], v[62:63], v[50:51], v[48:49]
  v_pk_mul_f32 v[56:57], v[56:57], v[32:33]
  v_pk_mul_f32 v[58:59], v[58:59], v[34:35]
  v_pk_mul_f32 v[60:61], v[60:61], v[36:37]
  v_pk_mul_f32 v[62:63], v[62:63], v[38:39]
  v_exp_f32 v56, v56
  v_exp_f32 v57, v57
  v_exp_f32 v58, v58
  v_exp_f32 v59, v59
  v_exp_f32 v60, v60
  v_exp_f32 v61, v61
  v_exp_f32 v62, v62
  v_exp_f32 v63, v63
  v_pk_add_f32 v[56:57], v[56:57], v[52:53]
  v_pk_add_f32 v[58:59], v[58:59], v[52:53]
  v_pk_add_f32 v[60:61], v[60:61], v[52:53]
  v_pk_add_f32 v[62:63], v[62:63], v[52:53]
  v_rcp_f32 v56, v56
  v_rcp_f32 v57, v57
  v_rcp_f32 v58, v58
  v_rcp_f32 v59, v59
  v_rcp_f32 v60, v60
  v_rcp_f32 v61, v61
  v_rcp_f32 v62, v62
  v_rcp_f32 v63, v63
  v_pk_mul_f32 v[32:33], v[32:33], v[56:57]
  v_pk_mul_f32 v[34:35], v[34:35], v[58:59]
  v_pk_mul_f32 v[36:37], v[36:37], v[60:61]
  v_pk_mul_f32 v[38:39], v[38:39], v[62:63]
  s_branch L_hd_57
L_hi_56:
L_hd_57:
  v_pk_add_f32 v[56:57], v[16:17], v[18:19]
  v_pk_mul_f32 v[58:59], v[16:17], v[16:17]
  v_pk_add_f32 v[60:61], v[32:33], v[34:35]
  v_pk_mul_f32 v[62:63], v[32:33], v[32:33]
  v_pk_fma_f32 v[58:59], v[18:19], v[18:19], v[58:59]
  v_pk_fma_f32 v[62:63], v[34:35], v[34:35], v[62:63]
  v_pk_fma_f32 v[56:57], v[60:61], s[72:73], v[56:57]
  v_pk_fma_f32 v[58:59], v[62:63], s[72:73], v[58:59]
  v_add_f32 v72, v56, v57
  v_add_f32_e64 v73, v58, v59
  v_pk_add_f32 v[64:65], v[20:21], v[22:23]
  v_pk_mul_f32 v[66:67], v[20:21], v[20:21]
  v_pk_add_f32 v[68:69], v[36:37], v[38:39]
  v_pk_mul_f32 v[70:71], v[36:37], v[36:37]
  v_pk_fma_f32 v[66:67], v[22:23], v[22:23], v[66:67]
  v_pk_fma_f32 v[70:71], v[38:39], v[38:39], v[70:71]
  v_pk_fma_f32 v[64:65], v[68:69], s[72:73], v[64:65]
  v_pk_fma_f32 v[66:67], v[70:71], s[72:73], v[66:67]
  v_add_f32 v76, v64, v65
  v_add_f32 v77, v66, v67
  v_permlane16_swap_b32 v72, v73
  s_nop 0
  v_permlane16_swap_b32 v76, v77
  v_add_f32 v72, v72, v73
  v_add_f32 v76, v76, v77
  s_nop 1
  v_permlane32_swap_b32 v72, v76
  v_add_f32 v72, v72, v76
  ds_write_b32 v14, v72
  s_waitcnt lgkmcnt(0)
  s_barrier
  s_cmp_lg_u32 s46, 0
  s_cbranch_scc1 L_w0_58
  ds_read_b64 v[72:73], v44 offset:0
  ds_read_b64 v[74:75], v44 offset:512
  ds_read_b64 v[76:77], v44 offset:1024
  ds_read_b64 v[78:79], v44 offset:1536
  v_mov_b32 v57, v3
  v_mov_b32_e64 v59, v3
  s_waitcnt lgkmcnt(0)
  v_pk_add_f32 v[72:73], v[72:73], v[74:75]
  v_pk_add_f32 v[76:77], v[76:77], v[78:79]
  v_add_f32 v56, v72, v76
  v_add_f32 v58, v73, v77
  s_cmp_eq_u32 s47, 0
  s_cbranch_scc1 L_pw_59
  buffer_store_dwordx4 v[56:59], v4, s[40:43], s64 offen
  s_branch L_pd_60
L_pw_59:
  buffer_store_dwordx4 v[56:59], v4, s[40:43], s64 offen sc1
L_pd_60:
  s_nop 1
L_w0_58:
  s_add_u32 s62, s57, 512
  s_add_u32 m0, s58, 49152
  s_nop 0
  buffer_load_dwordx4 v11, s[20:23], s62 offen lds
  s_add_u32 s62, s62, 32768
  s_add_u32 m0, s58, 50176
  s_nop 0
  buffer_load_dwordx4 v12, s[20:23], s62 offen lds
  s_add_u32 s62, s62, 32768
  s_add_u32 m0, s58, 51200
  s_nop 0
  buffer_load_dwordx4 v11, s[20:23], s62 offen lds
  s_add_u32 s62, s62, 32768
  s_add_u32 m0, s58, 52224
  s_nop 0
  buffer_load_dwordx4 v12, s[20:23], s62 offen lds
  s_cmp_ge_u32 s46, 4
  s_cbranch_scc1 L_hi_61
  s_branch L_hd_62
L_hi_61:
  v_pk_mul_f32 v[56:57], v[32:33], v[32:33]
  v_pk_mul_f32 v[58:59], v[34:35], v[34:35]
  v_pk_mul_f32 v[60:61], v[36:37], v[36:37]
  v_pk_mul_f32 v[62:63], v[38:39], v[38:39]
  v_pk_fma_f32 v[56:57], v[56:57], v[50:51], v[48:49]
  v_pk_fma_f32 v[58:59], v[58:59], v[50:51], v[48:49]
  v_pk_fma_f32 v[60:61], v[60:61], v[50:51], v[48:49]
  v_pk_fma_f32 v[62:63], v[62:63], v[50:51], v[48:49]
  v_pk_mul_f32 v[56:57], v[56:57], v[32:33]
  v_pk_mul_f32 v[58:59], v[58:59], v[34:35]
  v_pk_mul_f32 v[60:61], v[60:61], v[36:37]
  v_pk_mul_f32 v[62:63], v[62:63], v[38:39]
  v_exp_f32 v56, v56
  v_exp_f32 v57, v57
  v_exp_f32 v58, v58
  v_exp_f32 v59, v59
  v_exp_f32 v60, v60
  v_exp_f32 v61, v61
  v_exp_f32 v62, v62
  v_exp_f32_e64 v63, v63
  v_pk_add_f32 v[56:57], v[56:57], v[52:53]
  v_pk_add_f32 v[58:59], v[58:59], v[52:53]
  v_pk_add_f32 v[60:61], v[60:61], v[52:53]
  v_pk_add_f32 v[62:63], v[62:63], v[52:53]
  v_rcp_f32 v56, v56
  v_rcp_f32 v57, v57
  v_rcp_f32 v58, v58
  v_rcp_f32 v59, v59
  v_rcp_f32 v60, v60
  v_rcp_f32 v61, v61
  v_rcp_f32 v62, v62
  v_rcp_f32 v63, v63
  v_pk_mul_f32 v[32:33], v[32:33], v[56:57]
  v_pk_mul_f32 v[34:35], v[34:35], v[58:59]
  v_pk_mul_f32 v[36:37], v[36:37], v[60:61]
  v_pk_mul_f32 v[38:39], v[38:39], v[62:63]
L_hd_62:
  v_pk_mul_f32 v[56:57], v[24:25], v[24:25]
  v_pk_mul_f32 v[58:59], v[26:27], v[26:27]
  v_pk_mul_f32 v[60:61], v[28:29], v[28:29]
  v_pk_mul_f32 v[62:63], v[30:31], v[30:31]
  v_pk_fma_f32 v[56:57], v[56:57], v[50:51], v[48:49]
  v_pk_fma_f32 v[58:59], v[58:59], v[50:51], v[48:49]
  v_pk_fma_f32 v[60:61], v[60:61], v[50:51], v[48:49]
  v_pk_fma_f32 v[62:63], v[62:63], v[50:51], v[48:49]
  v_pk_mul_f32 v[56:57], v[56:57], v[24:25]
  v_pk_mul_f32 v[58:59], v[58:59], v[26:27]
  v_pk_mul_f32 v[60:61], v[60:61], v[28:29]
  v_pk_mul_f32 v[62:63], v[62:63], v[30:31]
  v_exp_f32 v56, v56
  v_exp_f32 v57, v57
  v_exp_f32 v58, v58
  v_exp_f32 v59, v59
  v_exp_f32 v60, v60
  v_exp_f32 v61, v61
  v_exp_f32 v62, v62
  v_exp_f32 v63, v63
  v_pk_add_f32 v[56:57], v[56:57], v[52:53]
  v_pk_add_f32 v[58:59], v[58:59], v[52:53]
  v_pk_add_f32 v[60:61], v[60:61], v[52:53]
  v_pk_add_f32 v[62:63], v[62:63], v[52:53]
  v_rcp_f32 v56, v56
  v_rcp_f32 v57, v57
  v_rcp_f32 v58, v58
  v_rcp_f32 v59, v59
  v_rcp_f32 v60, v60
  v_rcp_f32 v61, v61
  v_rcp_f32 v62, v62
  v_rcp_f32 v63, v63
  v_pk_mul_f32 v[24:25], v[24:25], v[56:57]
  v_pk_mul_f32 v[26:27], v[26:27], v[58:59]
  v_pk_mul_f32 v[28:29], v[28:29], v[60:61]
  v_pk_mul_f32 v[30:31], v[30:31], v[62:63]
  buffer_load_dwordx4 v[80:83], v45, s[40:43], s63 offen offset:0 sc1
  buffer_load_dwordx4 v[84:87], v45, s[40:43], s63 offen offset:1024 sc1
  buffer_load_dwordx4 v[88:91], v45, s[40:43], s63 offen offset:2048 sc1
  buffer_load_dwordx4 v[92:95], v45, s[40:43], s63 offen offset:3072 sc1
  v_cvt_pk_bf16_f32 v56, v24, v25
  v_cvt_pk_bf16_f32 v57, v26, v27
  ds_write_b64 v13, v[56:57] offset:0
  v_cvt_pk_bf16_f32 v58, v28, v29
  v_cvt_pk_bf16_f32 v59, v30, v31
  ds_write_b64 v13, v[58:59] offset:3328
  s_waitcnt vmcnt(8)
  ds_read_b128 v[164:167], v40 offset:0
  ds_read_b128 v[168:171], v41 offset:0
  ds_read_b128 v[172:175], v42 offset:0
  ds_read_b128 v[176:179], v43 offset:0
  s_mov_b32 s3, 131072
L_zlp_63:
  s_waitcnt vmcnt(0)
  v_xor_b32 v81, v81, v3
  v_xor_b32 v83, v83, v3
  v_xor_b32 v85, v85, v3
  v_xor_b32 v87, v87, v3
  v_xor_b32 v89, v89, v3
  v_xor_b32 v91, v91, v3
  v_xor_b32 v93, v93, v3
  v_xor_b32 v95, v95, v3
  v_or3_b32 v5, v81, v83, v85
  v_or3_b32 v6, v87, v89, v91
  v_or3_b32 v5, v5, v93, v95
  v_or_b32_e64 v5, v5, v6
  v_cmp_ne_u32 vcc, 0, v5
  s_cbranch_vccz L_zok_64
  buffer_load_dwordx4 v[80:83], v45, s[40:43], s63 offen offset:0 sc1
  buffer_load_dwordx4 v[84:87], v45, s[40:43], s63 offen offset:1024 sc1
  buffer_load_dwordx4 v[88:91], v45, s[40:43], s63 offen offset:2048 sc1
  buffer_load_dwordx4 v[92:95], v45, s[40:43], s63 offen offset:3072 sc1
  s_sub_u32 s3, s3, 1
  s_cmp_lg_u32 s3, 0
  s_cbranch_scc1 L_zlp_63
  s_waitcnt vmcnt(0)
L_zok_64:
  v_add_f32 v80, v80, v84
  v_add_f32 v81, v82, v86
  v_add_f32 v88, v88, v92
  v_add_f32 v90, v90, v94
  v_add_f32 v80, v80, v88
  v_add_f32 v81, v81, v90
  s_nop 1
  v_permlane32_swap_b32 v80, v81
  v_add_f32 v80, v80, v81
  v_mov_b32 v88, v80
  s_nop 1
  v_permlane16_swap_b32 v80, v88
  v_mov_b32 v81, v80
  v_mov_b32_e64 v89, v88
  s_nop 0
  v_permlane32_swap_b32 v80, v81
  v_permlane32_swap_b32 v88, v89
  v_mul_f32 v80, 0x3abe82fa, v80
  v_mul_f32 v81, 0x3abe82fa, v81
  v_fma_f32 v81, -v80, v80, v81
  v_max_f32_e64 v81, 0, v81
  v_add_f32 v81, 0x3727c5ac, v81
  v_rsq_f32 v96, v81
  v_sub_f32 v80, 0, v80
  v_mul_f32 v98, v80, v96
  v_mov_b32 v97, v96
  v_mov_b32_e64 v99, v98
  v_mul_f32 v88, 0x3abe82fa, v88
  v_mul_f32 v89, 0x3abe82fa, v89
  v_fma_f32 v89, -v88, v88, v89
  v_max_f32_e64 v89, 0, v89
  v_add_f32 v89, 0x3727c5ac, v89
  v_rsq_f32 v100, v89
  v_sub_f32 v88, 0, v88
  v_mul_f32 v102, v88, v100
  v_mov_b32 v101, v100
  v_mov_b32_e64 v103, v102
  v_pk_fma_f32 v[16:17], v[16:17], v[96:97], v[98:99]
  v_pk_fma_f32 v[18:19], v[18:19], v[96:97], v[98:99]
  v_mov_b32 v5, s67
  v_fmac_f32 v5, s66, v96
  v_mul_f32_e64 v6, s66, v98
  v_cvt_pk_bf16_f32 v56, v16, v17
  v_cvt_pk_bf16_f32 v57, v18, v19
  ds_write_b64 v7, v[56:57] offset:13312
  v_fma_f32 v32, v32, v5, v6
  v_fma_f32 v33, v33, v5, v6
  v_fma_f32 v34, v34, v5, v6
  v_fma_f32 v35, v35, v5, v6
  v_cvt_pk_bf16_f32 v58, v32, v33
  v_cvt_pk_bf16_f32 v59, v34, v35
  ds_write_b64 v15, v[58:59] offset:0
  v_pk_fma_f32 v[20:21], v[20:21], v[100:101], v[102:103]
  v_pk_fma_f32 v[22:23], v[22:23], v[100:101], v[102:103]
  v_mov_b32 v5, s67
  v_fmac_f32 v5, s66, v100
  v_mul_f32_e64 v6, s66, v102
  v_cvt_pk_bf16_f32 v60, v20, v21
  v_cvt_pk_bf16_f32 v61, v22, v23
  ds_write_b64 v7, v[60:61] offset:16640
  v_fma_f32 v36, v36, v5, v6
  v_fma_f32 v37, v37, v5, v6
  v_fma_f32 v38, v38, v5, v6
  v_fma_f32 v39, v39, v5, v6
  v_cvt_pk_bf16_f32 v62, v36, v37
  v_cvt_pk_bf16_f32 v63, v38, v39
  ds_write_b64 v15, v[62:63] offset:3328
  s_waitcnt lgkmcnt(0)
  s_barrier
  ds_read_b128 v[56:59], v46 offset:13312
  ds_read_b64 v[60:61], v47 offset:13312
  s_waitcnt lgkmcnt(1)
  buffer_store_dwordx4 v[56:59], v54, s[40:43], s69 offen sc1
  s_waitcnt lgkmcnt(0)
  buffer_store_dwordx2 v[60:61], v55, s[40:43], s69 offen offset:1024 sc1
  ds_read_b128 v[180:183], v40 offset:49152
  ds_read_b128 v[184:187], v41 offset:49152
  ds_read_b128 v[188:191], v42 offset:49152
  ds_read_b128 v[192:195], v43 offset:49152
  s_add_u32 s62, s57, 640
  s_add_u32 m0, s58, 0
  s_nop 0
  buffer_load_dwordx4 v11, s[20:23], s62 offen lds
  s_add_u32 s62, s62, 32768
  s_add_u32 m0, s58, 1024
  s_nop 0
  buffer_load_dwordx4 v12, s[20:23], s62 offen lds
  s_add_u32 s62, s62, 32768
  s_add_u32 m0, s58, 2048
  s_nop 0
  buffer_load_dwordx4 v11, s[20:23], s62 offen lds
  s_add_u32 s62, s62, 32768
  s_add_u32 m0, s58, 3072
  s_nop 0
  buffer_load_dwordx4 v12, s[20:23], s62 offen lds
  s_waitcnt vmcnt(4)
  s_waitcnt lgkmcnt(0)
  s_barrier
  s_cmp_lg_u32 s46, 0
  s_cbranch_scc1 L_w0_65
  s_mov_b64 exec, 0x1fe0
  buffer_store_dword v3, v2, s[40:43], 0 offen sc1
  s_mov_b64 exec, -1
L_w0_65:
  s_add_u32 s62, s57, 768
  s_add_u32 m0, s58, 49152
  s_nop 0
  buffer_load_dwordx4 v11, s[20:23], s62 offen lds
  s_add_u32 s62, s62, 32768
  s_add_u32 m0, s58, 50176
  s_nop 0
  buffer_load_dwordx4 v12, s[20:23], s62 offen lds
  s_add_u32 s62, s62, 32768
  s_add_u32 m0, s58, 51200
  s_nop 0
  buffer_load_dwordx4 v11, s[20:23], s62 offen lds
  s_add_u32 s62, s62, 32768
  s_add_u32 m0, s58, 52224
  s_nop 0
  buffer_load_dwordx4 v12, s[20:23], s62 offen lds
  s_waitcnt vmcnt(4)
  ds_read_b128 v[196:199], v40 offset:0
  ds_read_b128 v[200:203], v41 offset:0
  ds_read_b128 v[204:207], v42 offset:0
  ds_read_b128 v[208:211], v43 offset:0
  s_waitcnt lgkmcnt(0)
  s_add_u32 s62, s57, 896
  s_add_u32 m0, s58, 0
  s_nop 0
  buffer_load_dwordx4 v11, s[20:23], s62 offen lds
  s_add_u32 s62, s62, 32768
  s_add_u32 m0, s58, 1024
  s_nop 0
  buffer_load_dwordx4 v12, s[20:23], s62 offen lds
  s_add_u32 s62, s62, 32768
  s_add_u32 m0, s58, 2048
  s_nop 0
  buffer_load_dwordx4 v11, s[20:23], s62 offen lds
  s_add_u32 s62, s62, 32768
  s_add_u32 m0, s58, 3072
  s_nop 0
  buffer_load_dwordx4 v12, s[20:23], s62 offen lds
  s_lshl_b32 s64, s45, 3
  s_add_u32 s64, s64, s46
  s_mul_i32 s64, s64, 2816
  v_min_u32 v5, 21, v1
  v_lshlrev_b32 v5, 7, v5
  buffer_load_dword v247, v5, s[28:31], s64 offen
  s_lshr_b32 s60, s46, 1
  s_and_b32 s61, s46, 1
  v_and_b32 v5, 31, v1
  v_lshlrev_b32_e64 v7, 1, v5
  s_lshl_b32 s64, s50, 7
  s_lshl_b32 s65, s61, 6
  s_add_u32 s64, s64, s65
  buffer_load_ushort v103, v7, s[24:27], s64 offen
  v_and_b32 v5, 15, v1
  v_lshrrev_b32 v6, 4, v1
  v_and_b32 v7, 1, v6
  v_lshlrev_b32 v7, 1, v7
  v_bfe_u32 v100, v5, 1, 1
  v_add_u32 v7, v7, v100
  v_add_u32 v7, s60, v7
  v_and_b32 v7, 3, v7
  v_lshlrev_b32 v7, 4, v7
  v_and_b32_e64 v100, 1, v5
  v_lshl_add_u32 v7, v100, 3, v7
  v_lshrrev_b32 v6, 1, v6
  v_lshrrev_b32 v5, 2, v5
  v_lshl_add_u32 v5, v6, 3, v5
  v_mul_u32_u24 v5, 192, v5
  v_add_u32_e64 v100, v5, v7
  s_mul_i32 s64, s60, 6144
  s_add_u32 s65, s64, 40960
  v_add_u32_e64 v100, s65, v100
  v_add_u32 v101, 49152, v100
  v_add_u32 v102, 98304, v100
  s_mul_i32 s64, s61, 3072
  s_add_u32 s59, s65, s64
  s_mul_i32 s63, s49, 393216
  s_add_u32 s63, s63, s64
  s_mul_i32 s64, s60, 98304
  s_add_u32 s63, s63, s64
  s_add_u32 s63, s63, 4194304
  v_lshrrev_b32 v5, 3, v1
  v_and_b32 v6, 7, v1
  v_and_b32 v104, 6, v5
  v_xor_b32 v104, v104, v6
  v_lshlrev_b32 v104, 4, v104
  v_lshl_add_u32 v104, v5, 10, v104
  s_lshl_b32 s64, s46, 13
  s_lshl_b32 s65, s49, 7
  s_add_u32 s64, s64, s65
  v_add_u32 v104, s64, v104
  v_and_b32 v5, 15, v1
  v_lshrrev_b32 v6, 4, v1
  v_and_b32 v7, 1, v6
  v_lshrrev_b32 v106, 2, v5
  v_lshl_add_u32 v106, v7, 2, v106
  v_and_b32_e64 v7, 6, v106
  v_bfe_u32 v105, v5, 1, 1
  s_and_b32 s64, s46, 4
  v_add_u32 v105, s64, v105
  v_xor_b32 v105, v105, v7
  v_lshlrev_b32 v105, 4, v105
  v_lshl_add_u32 v105, v106, 7, v105
  v_and_b32_e64 v7, 1, v5
  v_lshl_add_u32 v105, v7, 3, v105
  v_lshrrev_b32_e64 v6, 1, v6
  v_lshl_add_u32 v105, v6, 11, v105
  v_xor_b32 v106, 32, v105
  s_lshl_b32 s97, s46, 10
  s_add_u32 m0, s97, 16384
  s_mov_b32 s97, 0
  buffer_load_dwordx4 v104, s[28:31], s97 offen lds
  s_lshl_b32 s97, s46, 10
  s_add_u32 m0, s97, 24576
  s_mov_b32 s97, 65536
  buffer_load_dwordx4 v104, s[28:31], s97 offen lds
  s_lshl_b32 s97, s46, 10
  s_add_u32 m0, s97, 32768
  s_mov_b32 s97, 131072
  buffer_load_dwordx4 v104, s[28:31], s97 offen lds
  s_waitcnt vmcnt(9)
  ds_read_b128 v[212:215], v40 offset:49152
  ds_read_b128 v[216:219], v41 offset:49152
  ds_read_b128 v[220:223], v42 offset:49152
  ds_read_b128 v[224:227], v43 offset:49152
  s_waitcnt vmcnt(5)
  ds_read_b128 v[228:231], v40 offset:0
  ds_read_b128 v[232:235], v41 offset:0
  ds_read_b128 v[236:239], v42 offset:0
  ds_read_b128 v[240:243], v43 offset:0
  s_waitcnt lgkmcnt(0)
  s_cmp_lg_u32 s46, 1
  s_cbranch_scc1 L_w0_66
  s_lshl_b32 s96, s49, 3
  s_add_u32 s96, s96, s44
  s_lshl_b32 s96, s96, 10
  s_add_u32 s96, s96, 32768
  v_lshlrev_b32 v5, 5, v1
  s_mov_b32 exec_lo, 0xffffffff
  s_mov_b32 exec_hi, 0x0
  s_mov_b32 s3, 131072
L_poll_67:
  buffer_load_dword v6, v5, s[40:43], s96 offen sc1
  s_waitcnt vmcnt(0)
  v_cmp_ne_u32 vcc, v6, v3
  s_cbranch_vccz L_pok_68
  s_sub_u32 s3, s3, 1
  s_cmp_lg_u32 s3, 0
  s_cbranch_scc1 L_poll_67
L_pok_68:
  s_mov_b64 exec, -1
L_w0_66:
  s_barrier
  s_add_u32 m0, s59, 0
  s_add_u32 s62, s63, 0
  buffer_load_dwordx4 v4, s[40:43], s62 offen offset:0 sc1 lds
  buffer_load_dwordx4 v4, s[40:43], s62 offen offset:1024 sc1 lds
  buffer_load_dwordx4 v4, s[40:43], s62 offen offset:2048 sc1 lds
  s_barrier
  s_add_u32 m0, s59, 24576
  s_add_u32 s62, s63, 6144
  buffer_load_dwordx4 v4, s[40:43], s62 offen offset:0 sc1 lds
  buffer_load_dwordx4 v4, s[40:43], s62 offen offset:1024 sc1 lds
  buffer_load_dwordx4 v4, s[40:43], s62 offen offset:2048 sc1 lds
  s_barrier
  s_add_u32 m0, s59, 49152
  s_add_u32 s62, s63, 12288
  buffer_load_dwordx4 v4, s[40:43], s62 offen offset:0 sc1 lds
  buffer_load_dwordx4 v4, s[40:43], s62 offen offset:1024 sc1 lds
  buffer_load_dwordx4 v4, s[40:43], s62 offen offset:2048 sc1 lds
  s_waitcnt vmcnt(6)
  s_barrier
  ds_read_b64_tr_b16 v[64:65], v100 offset:0
  ds_read_b64_tr_b16 v[66:67], v100 offset:768
  ds_read_b64_tr_b16 v[68:69], v100 offset:64
  ds_read_b64_tr_b16 v[70:71], v100 offset:832
  ds_read_b64_tr_b16 v[72:73], v100 offset:128
  ds_read_b64_tr_b16 v[74:75], v100 offset:896
  ds_read_b64_tr_b16 v[76:77], v100 offset:3072
  ds_read_b64_tr_b16 v[78:79], v100 offset:3840
  ds_read_b64_tr_b16 v[80:81], v100 offset:3136
  ds_read_b64_tr_b16 v[82:83], v100 offset:3904
  ds_read_b64_tr_b16 v[84:85], v100 offset:3200
  ds_read_b64_tr_b16 v[86:87], v100 offset:3968
  s_waitcnt vmcnt(3)
  s_barrier
  s_waitcnt lgkmcnt(6)
  v_mfma_f32_32x32x16_bf16 v[16:31], v[64:67], v[116:119], 0
  ds_read_b64_tr_b16 v[88:89], v100 offset:24576
  ds_read_b64_tr_b16 v[90:91], v100 offset:25344
  s_cmp_ge_u32 s46, 4
  s_cbranch_scc1 L_ho_69
  s_add_u32 m0, s59, 73728
  s_add_u32 s62, s63, 18432
  buffer_load_dwordx4 v4, s[40:43], s62 offen offset:0 sc1 lds
  buffer_load_dwordx4 v4, s[40:43], s62 offen offset:1024 sc1 lds
  buffer_load_dwordx4 v4, s[40:43], s62 offen offset:2048 sc1 lds
  s_add_u32 m0, s59, 98304
  s_add_u32 s62, s63, 24576
  buffer_load_dwordx4 v4, s[40:43], s62 offen offset:0 sc1 lds
  buffer_load_dwordx4 v4, s[40:43], s62 offen offset:1024 sc1 lds
  buffer_load_dwordx4 v4, s[40:43], s62 offen offset:2048 sc1 lds
L_ho_69:
  v_mfma_f32_32x32x16_bf16 v[32:47], v[68:71], v[116:119], 0
  ds_read_b64_tr_b16 v[92:93], v100 offset:24640
  ds_read_b64_tr_b16 v[94:95], v100 offset:25408
  v_mfma_f32_32x32x16_bf16 v[48:63], v[72:75], v[116:119], 0
  ds_read_b64_tr_b16 v[96:97], v100 offset:24704
  ds_read_b64_tr_b16 v[98:99], v100 offset:25472
  s_waitcnt lgkmcnt(6)
  v_mfma_f32_32x32x16_bf16 v[16:31], v[76:79], v[120:123], v[16:31]
  ds_read_b64_tr_b16 v[64:65], v100 offset:27648
  ds_read_b64_tr_b16 v[66:67], v100 offset:28416
  s_cmp_lt_u32 s46, 4
  s_cbranch_scc1 L_ho_70
  s_add_u32 m0, s59, 73728
  s_add_u32 s62, s63, 18432
  buffer_load_dwordx4 v4, s[40:43], s62 offen offset:0 sc1 lds
  buffer_load_dwordx4 v4, s[40:43], s62 offen offset:1024 sc1 lds
  buffer_load_dwordx4 v4, s[40:43], s62 offen offset:2048 sc1 lds
  s_add_u32 m0, s59, 98304
  s_add_u32 s62, s63, 24576
  buffer_load_dwordx4 v4, s[40:43], s62 offen offset:0 sc1 lds
  buffer_load_dwordx4 v4, s[40:43], s62 offen offset:1024 sc1 lds
  buffer_load_dwordx4 v4, s[40:43], s62 offen offset:2048 sc1 lds
L_ho_70:
  v_mfma_f32_32x32x16_bf16 v[32:47], v[80:83], v[120:123], v[32:47]
  ds_read_b64_tr_b16 v[68:69], v100 offset:27712
  ds_read_b64_tr_b16 v[70:71], v100 offset:28480
  v_mfma_f32_32x32x16_bf16 v[48:63], v[84:87], v[120:123], v[48:63]
  ds_read_b64_tr_b16 v[72:73], v100 offset:27776
  ds_read_b64_tr_b16 v[74:75], v100 offset:28544
  s_waitcnt vmcnt(6)
  s_barrier
  s_waitcnt lgkmcnt(6)
  v_mfma_f32_32x32x16_bf16 v[16:31], v[88:91], v[124:127], v[16:31]
  ds_read_b64_tr_b16 v[76:77], v101 offset:0
  ds_read_b64_tr_b16 v[78:79], v101 offset:768
  s_cmp_ge_u32 s46, 4
  s_cbranch_scc1 L_ho_71
  s_add_u32 m0, s59, 0
  s_add_u32 s62, s63, 30720
  buffer_load_dwordx4 v4, s[40:43], s62 offen offset:0 sc1 lds
  buffer_load_dwordx4 v4, s[40:43], s62 offen offset:1024 sc1 lds
  buffer_load_dwordx4 v4, s[40:43], s62 offen offset:2048 sc1 lds
L_ho_71:
  v_mfma_f32_32x32x16_bf16 v[32:47], v[92:95], v[124:127], v[32:47]
  ds_read_b64_tr_b16 v[80:81], v101 offset:64
  ds_read_b64_tr_b16 v[82:83], v101 offset:832
  v_mfma_f32_32x32x16_bf16 v[48:63], v[96:99], v[124:127], v[48:63]
  ds_read_b64_tr_b16 v[84:85], v101 offset:128
  ds_read_b64_tr_b16 v[86:87], v101 offset:896
  s_waitcnt lgkmcnt(6)
  v_mfma_f32_32x32x16_bf16 v[16:31], v[64:67], v[128:131], v[16:31]
  ds_read_b64_tr_b16 v[88:89], v101 offset:3072
  ds_read_b64_tr_b16 v[90:91], v101 offset:3840
  s_cmp_lt_u32 s46, 4
  s_cbranch_scc1 L_ho_72
  s_add_u32 m0, s59, 0
  s_add_u32 s62, s63, 30720
  buffer_load_dwordx4 v4, s[40:43], s62 offen offset:0 sc1 lds
  buffer_load_dwordx4 v4, s[40:43], s62 offen offset:1024 sc1 lds
  buffer_load_dwordx4 v4, s[40:43], s62 offen offset:2048 sc1 lds
L_ho_72:
  v_mfma_f32_32x32x16_bf16 v[32:47], v[68:71], v[128:131], v[32:47]
  ds_read_b64_tr_b16 v[92:93], v101 offset:3136
  ds_read_b64_tr_b16 v[94:95], v101 offset:3904
  v_mfma_f32_32x32x16_bf16 v[48:63], v[72:75], v[128:131], v[48:63]
  ds_read_b64_tr_b16 v[96:97], v101 offset:3200
  ds_read_b64_tr_b16 v[98:99], v101 offset:3968
  s_waitcnt vmcnt(6)
  s_barrier
  s_waitcnt lgkmcnt(6)
  v_mfma_f32_32x32x16_bf16 v[16:31], v[76:79], v[132:135], v[16:31]
  ds_read_b64_tr_b16 v[64:65], v101 offset:24576
  ds_read_b64_tr_b16 v[66:67], v101 offset:25344
  s_cmp_ge_u32 s46, 4
  s_cbranch_scc1 L_ho_73
  s_add_u32 m0, s59, 24576
  s_add_u32 s62, s63, 36864
  buffer_load_dwordx4 v4, s[40:43], s62 offen offset:0 sc1 lds
  buffer_load_dwordx4 v4, s[40:43], s62 offen offset:1024 sc1 lds
  buffer_load_dwordx4 v4, s[40:43], s62 offen offset:2048 sc1 lds
L_ho_73:
  v_mfma_f32_32x32x16_bf16 v[32:47], v[80:83], v[132:135], v[32:47]
  ds_read_b64_tr_b16 v[68:69], v101 offset:24640
  ds_read_b64_tr_b16 v[70:71], v101 offset:25408
  v_mfma_f32_32x32x16_bf16 v[48:63], v[84:87], v[132:135], v[48:63]
  ds_read_b64_tr_b16 v[72:73], v101 offset:24704
  ds_read_b64_tr_b16 v[74:75], v101 offset:25472
  s_waitcnt lgkmcnt(6)
  v_mfma_f32_32x32x16_bf16 v[16:31], v[88:91], v[136:139], v[16:31]
  ds_read_b64_tr_b16 v[76:77], v101 offset:27648
  ds_read_b64_tr_b16 v[78:79], v101 offset:28416
  s_cmp_lt_u32 s46, 4
  s_cbranch_scc1 L_ho_74
  s_add_u32 m0, s59, 24576
  s_add_u32 s62, s63, 36864
  buffer_load_dwordx4 v4, s[40:43], s62 offen offset:0 sc1 lds
  buffer_load_dwordx4 v4, s[40:43], s62 offen offset:1024 sc1 lds
  buffer_load_dwordx4 v4, s[40:43], s62 offen offset:2048 sc1 lds
L_ho_74:
  v_mfma_f32_32x32x16_bf16 v[32:47], v[92:95], v[136:139], v[32:47]
  ds_read_b64_tr_b16 v[80:81], v101 offset:27712
  ds_read_b64_tr_b16 v[82:83], v101 offset:28480
  v_mfma_f32_32x32x16_bf16 v[48:63], v[96:99], v[136:139], v[48:63]
  ds_read_b64_tr_b16 v[84:85], v101 offset:27776
  ds_read_b64_tr_b16 v[86:87], v101 offset:28544
  s_waitcnt vmcnt(6)
  s_barrier
  s_waitcnt lgkmcnt(6)
  v_mfma_f32_32x32x16_bf16 v[16:31], v[64:67], v[140:143], v[16:31]
  ds_read_b64_tr_b16 v[88:89], v102 offset:0
  ds_read_b64_tr_b16 v[90:91], v102 offset:768
  s_cmp_ge_u32 s46, 4
  s_cbranch_scc1 L_ho_75
  s_add_u32 m0, s59, 49152
  s_add_u32 s62, s63, 43008
  buffer_load_dwordx4 v4, s[40:43], s62 offen offset:0 sc1 lds
  buffer_load_dwordx4 v4, s[40:43], s62 offen offset:1024 sc1 lds
  buffer_load_dwordx4 v4, s[40:43], s62 offen offset:2048 sc1 lds
L_ho_75:
  v_mfma_f32_32x32x16_bf16 v[32:47], v[68:71], v[140:143], v[32:47]
  ds_read_b64_tr_b16 v[92:93], v102 offset:64
  ds_read_b64_tr_b16 v[94:95], v102 offset:832
  v_mfma_f32_32x32x16_bf16 v[48:63], v[72:75], v[140:143], v[48:63]
  ds_read_b64_tr_b16 v[96:97], v102 offset:128
  ds_read_b64_tr_b16 v[98:99], v102 offset:896
  s_waitcnt lgkmcnt(6)
  v_mfma_f32_32x32x16_bf16 v[16:31], v[76:79], v[144:147], v[16:31]
  ds_read_b64_tr_b16 v[64:65], v102 offset:3072
  ds_read_b64_tr_b16 v[66:67], v102 offset:3840
  s_cmp_lt_u32 s46, 4
  s_cbranch_scc1 L_ho_76
  s_add_u32 m0, s59, 49152
  s_add_u32 s62, s63, 43008
  buffer_load_dwordx4 v4, s[40:43], s62 offen offset:0 sc1 lds
  buffer_load_dwordx4 v4, s[40:43], s62 offen offset:1024 sc1 lds
  buffer_load_dwordx4 v4, s[40:43], s62 offen offset:2048 sc1 lds
L_ho_76:
  v_mfma_f32_32x32x16_bf16 v[32:47], v[80:83], v[144:147], v[32:47]
  ds_read_b64_tr_b16 v[68:69], v102 offset:3136
  ds_read_b64_tr_b16 v[70:71], v102 offset:3904
  v_mfma_f32_32x32x16_bf16 v[48:63], v[84:87], v[144:147], v[48:63]
  ds_read_b64_tr_b16 v[72:73], v102 offset:3200
  ds_read_b64_tr_b16 v[74:75], v102 offset:3968
  s_waitcnt vmcnt(6)
  s_barrier
  s_waitcnt lgkmcnt(6)
  v_mfma_f32_32x32x16_bf16 v[16:31], v[88:91], v[148:151], v[16:31]
  ds_read_b64_tr_b16 v[76:77], v100 offset:0
  ds_read_b64_tr_b16 v[78:79], v100 offset:768
  s_cmp_ge_u32 s46, 4
  s_cbranch_scc1 L_ho_77
  s_add_u32 m0, s59, 73728
  s_add_u32 s62, s63, 49152
  buffer_load_dwordx4 v4, s[40:43], s62 offen offset:0 sc1 lds
  buffer_load_dwordx4 v4, s[40:43], s62 offen offset:1024 sc1 lds
  buffer_load_dwordx4 v4, s[40:43], s62 offen offset:2048 sc1 lds
L_ho_77:
  v_mfma_f32_32x32x16_bf16 v[32:47], v[92:95], v[148:151], v[32:47]
  ds_read_b64_tr_b16 v[80:81], v100 offset:64
  ds_read_b64_tr_b16 v[82:83], v100 offset:832
  v_mfma_f32_32x32x16_bf16 v[48:63], v[96:99], v[148:151], v[48:63]
  ds_read_b64_tr_b16 v[84:85], v100 offset:128
  ds_read_b64_tr_b16 v[86:87], v100 offset:896
  s_waitcnt lgkmcnt(6)
  v_mfma_f32_32x32x16_bf16 v[16:31], v[64:67], v[152:155], v[16:31]
  ds_read_b64_tr_b16 v[88:89], v100 offset:3072
  ds_read_b64_tr_b16 v[90:91], v100 offset:3840
  s_cmp_lt_u32 s46, 4
  s_cbranch_scc1 L_ho_78
  s_add_u32 m0, s59, 73728
  s_add_u32 s62, s63, 49152
  buffer_load_dwordx4 v4, s[40:43], s62 offen offset:0 sc1 lds
  buffer_load_dwordx4 v4, s[40:43], s62 offen offset:1024 sc1 lds
  buffer_load_dwordx4 v4, s[40:43], s62 offen offset:2048 sc1 lds
L_ho_78:
  v_mfma_f32_32x32x16_bf16 v[32:47], v[68:71], v[152:155], v[32:47]
  ds_read_b64_tr_b16 v[92:93], v100 offset:3136
  ds_read_b64_tr_b16 v[94:95], v100 offset:3904
  v_mfma_f32_32x32x16_bf16 v[48:63], v[72:75], v[152:155], v[48:63]
  ds_read_b64_tr_b16 v[96:97], v100 offset:3200
  ds_read_b64_tr_b16 v[98:99], v100 offset:3968
  s_waitcnt vmcnt(6)
  s_barrier
  s_waitcnt lgkmcnt(6)
  v_mfma_f32_32x32x16_bf16 v[16:31], v[76:79], v[156:159], v[16:31]
  ds_read_b64_tr_b16 v[64:65], v100 offset:24576
  ds_read_b64_tr_b16 v[66:67], v100 offset:25344
  s_cmp_ge_u32 s46, 4
  s_cbranch_scc1 L_ho_79
  s_add_u32 m0, s59, 98304
  s_add_u32 s62, s63, 55296
  buffer_load_dwordx4 v4, s[40:43], s62 offen offset:0 sc1 lds
  buffer_load_dwordx4 v4, s[40:43], s62 offen offset:1024 sc1 lds
  buffer_load_dwordx4 v4, s[40:43], s62 offen offset:2048 sc1 lds
L_ho_79:
  v_mfma_f32_32x32x16_bf16 v[32:47], v[80:83], v[156:159], v[32:47]
  ds_read_b64_tr_b16 v[68:69], v100 offset:24640
  ds_read_b64_tr_b16 v[70:71], v100 offset:25408
  v_mfma_f32_32x32x16_bf16 v[48:63], v[84:87], v[156:159], v[48:63]
  ds_read_b64_tr_b16 v[72:73], v100 offset:24704
  ds_read_b64_tr_b16 v[74:75], v100 offset:25472
  s_waitcnt lgkmcnt(6)
  v_mfma_f32_32x32x16_bf16 v[16:31], v[88:91], v[160:163], v[16:31]
  ds_read_b64_tr_b16 v[76:77], v100 offset:27648
  ds_read_b64_tr_b16 v[78:79], v100 offset:28416
  s_cmp_lt_u32 s46, 4
  s_cbranch_scc1 L_ho_80
  s_add_u32 m0, s59, 98304
  s_add_u32 s62, s63, 55296
  buffer_load_dwordx4 v4, s[40:43], s62 offen offset:0 sc1 lds
  buffer_load_dwordx4 v4, s[40:43], s62 offen offset:1024 sc1 lds
  buffer_load_dwordx4 v4, s[40:43], s62 offen offset:2048 sc1 lds
L_ho_80:
  v_mfma_f32_32x32x16_bf16 v[32:47], v[92:95], v[160:163], v[32:47]
  ds_read_b64_tr_b16 v[80:81], v100 offset:27712
  ds_read_b64_tr_b16 v[82:83], v100 offset:28480
  v_mfma_f32_32x32x16_bf16 v[48:63], v[96:99], v[160:163], v[48:63]
  ds_read_b64_tr_b16 v[84:85], v100 offset:27776
  ds_read_b64_tr_b16 v[86:87], v100 offset:28544
  s_waitcnt vmcnt(6)
  s_barrier
  s_waitcnt lgkmcnt(6)
  v_mfma_f32_32x32x16_bf16 v[16:31], v[64:67], v[164:167], v[16:31]
  ds_read_b64_tr_b16 v[116:117], v105 offset:16384
  ds_read_b64_tr_b16 v[118:119], v105 offset:17408
  s_cmp_ge_u32 s46, 4
  s_cbranch_scc1 L_ho_81
  s_add_u32 m0, s59, 0
  s_add_u32 s62, s63, 61440
  buffer_load_dwordx4 v4, s[40:43], s62 offen offset:0 sc1 lds
  buffer_load_dwordx4 v4, s[40:43], s62 offen offset:1024 sc1 lds
  buffer_load_dwordx4 v4, s[40:43], s62 offen offset:2048 sc1 lds
L_ho_81:
  ds_read_b64_tr_b16 v[120:121], v106 offset:16384
  ds_read_b64_tr_b16 v[122:123], v106 offset:17408
  v_mfma_f32_32x32x16_bf16 v[32:47], v[68:71], v[164:167], v[32:47]
  ds_read_b64_tr_b16 v[124:125], v105 offset:20480
  ds_read_b64_tr_b16 v[126:127], v105 offset:21504
  ds_read_b64_tr_b16 v[88:89], v101 offset:0
  ds_read_b64_tr_b16 v[90:91], v101 offset:768
  v_mfma_f32_32x32x16_bf16 v[48:63], v[72:75], v[164:167], v[48:63]
  ds_read_b64_tr_b16 v[92:93], v101 offset:64
  ds_read_b64_tr_b16 v[94:95], v101 offset:832
  ds_read_b64_tr_b16 v[96:97], v101 offset:128
  ds_read_b64_tr_b16 v[98:99], v101 offset:896
  s_waitcnt lgkmcnt(12)
  v_mfma_f32_32x32x16_bf16 v[16:31], v[76:79], v[168:171], v[16:31]
  ds_read_b64_tr_b16 v[128:129], v106 offset:20480
  ds_read_b64_tr_b16 v[130:131], v106 offset:21504
  s_cmp_lt_u32 s46, 4
  s_cbranch_scc1 L_ho_82
  s_add_u32 m0, s59, 0
  s_add_u32 s62, s63, 61440
  buffer_load_dwordx4 v4, s[40:43], s62 offen offset:0 sc1 lds
  buffer_load_dwordx4 v4, s[40:43], s62 offen offset:1024 sc1 lds
  buffer_load_dwordx4 v4, s[40:43], s62 offen offset:2048 sc1 lds
L_ho_82:
  ds_read_b64_tr_b16 v[132:133], v105 offset:24576
  ds_read_b64_tr_b16 v[134:135], v105 offset:25600
  v_mfma_f32_32x32x16_bf16 v[32:47], v[80:83], v[168:171], v[32:47]
  ds_read_b64_tr_b16 v[136:137], v106 offset:24576
  ds_read_b64_tr_b16 v[138:139], v106 offset:25600
  ds_read_b64_tr_b16 v[64:65], v101 offset:3072
  ds_read_b64_tr_b16 v[66:67], v101 offset:3840
  v_mfma_f32_32x32x16_bf16 v[48:63], v[84:87], v[168:171], v[48:63]
  ds_read_b64_tr_b16 v[68:69], v101 offset:3136
  ds_read_b64_tr_b16 v[70:71], v101 offset:3904
  ds_read_b64_tr_b16 v[72:73], v101 offset:3200
  ds_read_b64_tr_b16 v[74:75], v101 offset:3968
  s_waitcnt vmcnt(6)
  s_barrier
  s_waitcnt lgkmcnt(12)
  v_mfma_f32_32x32x16_bf16 v[16:31], v[88:91], v[172:175], v[16:31]
  ds_read_b64_tr_b16 v[140:141], v105 offset:28672
  ds_read_b64_tr_b16 v[142:143], v105 offset:29696
  s_cmp_ge_u32 s46, 4
  s_cbranch_scc1 L_ho_83
  s_add_u32 m0, s59, 24576
  s_add_u32 s62, s63, 67584
  buffer_load_dwordx4 v4, s[40:43], s62 offen offset:0 sc1 lds
  buffer_load_dwordx4 v4, s[40:43], s62 offen offset:1024 sc1 lds
  buffer_load_dwordx4 v4, s[40:43], s62 offen offset:2048 sc1 lds
L_ho_83:
  ds_read_b64_tr_b16 v[144:145], v106 offset:28672
  ds_read_b64_tr_b16 v[146:147], v106 offset:29696
  v_mfma_f32_32x32x16_bf16 v[32:47], v[92:95], v[172:175], v[32:47]
  ds_read_b64_tr_b16 v[148:149], v105 offset:32768
  ds_read_b64_tr_b16 v[150:151], v105 offset:33792
  ds_read_b64_tr_b16 v[76:77], v101 offset:24576
  ds_read_b64_tr_b16 v[78:79], v101 offset:25344
  v_mfma_f32_32x32x16_bf16 v[48:63], v[96:99], v[172:175], v[48:63]
  ds_read_b64_tr_b16 v[80:81], v101 offset:24640
  ds_read_b64_tr_b16 v[82:83], v101 offset:25408
  ds_read_b64_tr_b16 v[84:85], v101 offset:24704
  ds_read_b64_tr_b16 v[86:87], v101 offset:25472
  s_waitcnt lgkmcnt(12)
  v_mfma_f32_32x32x16_bf16 v[16:31], v[64:67], v[176:179], v[16:31]
  ds_read_b64_tr_b16 v[152:153], v106 offset:32768
  ds_read_b64_tr_b16 v[154:155], v106 offset:33792
  s_cmp_lt_u32 s46, 4
  s_cbranch_scc1 L_ho_84
  s_add_u32 m0, s59, 24576
  s_add_u32 s62, s63, 67584
  buffer_load_dwordx4 v4, s[40:43], s62 offen offset:0 sc1 lds
  buffer_load_dwordx4 v4, s[40:43], s62 offen offset:1024 sc1 lds
  buffer_load_dwordx4 v4, s[40:43], s62 offen offset:2048 sc1 lds
L_ho_84:
  ds_read_b64_tr_b16 v[156:157], v105 offset:36864
  ds_read_b64_tr_b16 v[158:159], v105 offset:37888
  v_mfma_f32_32x32x16_bf16 v[32:47], v[68:71], v[176:179], v[32:47]
  ds_read_b64_tr_b16 v[160:161], v106 offset:36864
  ds_read_b64_tr_b16 v[162:163], v106 offset:37888
  ds_read_b64_tr_b16 v[88:89], v101 offset:27648
  ds_read_b64_tr_b16 v[90:91], v101 offset:28416
  v_mfma_f32_32x32x16_bf16 v[48:63], v[72:75], v[176:179], v[48:63]
  ds_read_b64_tr_b16 v[92:93], v101 offset:27712
  ds_read_b64_tr_b16 v[94:95], v101 offset:28480
  ds_read_b64_tr_b16 v[96:97], v101 offset:27776
  ds_read_b64_tr_b16 v[98:99], v101 offset:28544
  s_waitcnt vmcnt(6)
  s_barrier
  s_waitcnt lgkmcnt(12)
  v_mfma_f32_32x32x16_bf16 v[16:31], v[76:79], v[180:183], v[16:31]
  ds_read_b64_tr_b16 v[64:65], v102 offset:0
  ds_read_b64_tr_b16 v[66:67], v102 offset:768
  s_cmp_ge_u32 s46, 4
  s_cbranch_scc1 L_ho_85
  s_add_u32 m0, s59, 49152
  s_add_u32 s62, s63, 73728
  buffer_load_dwordx4 v4, s[40:43], s62 offen offset:0 sc1 lds
  buffer_load_dwordx4 v4, s[40:43], s62 offen offset:1024 sc1 lds
  buffer_load_dwordx4 v4, s[40:43], s62 offen offset:2048 sc1 lds
L_ho_85:
  v_mfma_f32_32x32x16_bf16 v[32:47], v[80:83], v[180:183], v[32:47]
  ds_read_b64_tr_b16 v[68:69], v102 offset:64
  ds_read_b64_tr_b16 v[70:71], v102 offset:832
  v_mfma_f32_32x32x16_bf16 v[48:63], v[84:87], v[180:183], v[48:63]
  ds_read_b64_tr_b16 v[72:73], v102 offset:128
  ds_read_b64_tr_b16 v[74:75], v102 offset:896
  s_waitcnt lgkmcnt(6)
  v_mfma_f32_32x32x16_bf16 v[16:31], v[88:91], v[184:187], v[16:31]
  ds_read_b64_tr_b16 v[76:77], v102 offset:3072
  ds_read_b64_tr_b16 v[78:79], v102 offset:3840
  s_cmp_lt_u32 s46, 4
  s_cbranch_scc1 L_ho_86
  s_add_u32 m0, s59, 49152
  s_add_u32 s62, s63, 73728
  buffer_load_dwordx4 v4, s[40:43], s62 offen offset:0 sc1 lds
  buffer_load_dwordx4 v4, s[40:43], s62 offen offset:1024 sc1 lds
  buffer_load_dwordx4 v4, s[40:43], s62 offen offset:2048 sc1 lds
L_ho_86:
  v_mfma_f32_32x32x16_bf16 v[32:47], v[92:95], v[184:187], v[32:47]
  ds_read_b64_tr_b16 v[80:81], v102 offset:3136
  ds_read_b64_tr_b16 v[82:83], v102 offset:3904
  v_mfma_f32_32x32x16_bf16 v[48:63], v[96:99], v[184:187], v[48:63]
  ds_read_b64_tr_b16 v[84:85], v102 offset:3200
  ds_read_b64_tr_b16 v[86:87], v102 offset:3968
  s_waitcnt vmcnt(6)
  s_barrier
  s_waitcnt lgkmcnt(6)
  v_mfma_f32_32x32x16_bf16 v[16:31], v[64:67], v[188:191], v[16:31]
  ds_read_b64_tr_b16 v[88:89], v100 offset:0
  ds_read_b64_tr_b16 v[90:91], v100 offset:768
  s_cmp_ge_u32 s46, 4
  s_cbranch_scc1 L_ho_87
  s_lshl_b32 s97, s46, 10
  s_add_u32 m0, s97, 16384
  s_mov_b32 s97, 196608
  buffer_load_dwordx4 v104, s[28:31], s97 offen lds
  s_lshl_b32 s97, s46, 10
  s_add_u32 m0, s97, 24576
  s_mov_b32 s97, 262144
  buffer_load_dwordx4 v104, s[28:31], s97 offen lds
  s_lshl_b32 s97, s46, 10
  s_add_u32 m0, s97, 32768
  s_mov_b32 s97, 327680
  buffer_load_dwordx4 v104, s[28:31], s97 offen lds
  s_add_u32 m0, s59, 73728
  s_add_u32 s62, s63, 79872
  buffer_load_dwordx4 v4, s[40:43], s62 offen offset:0 sc1 lds
  buffer_load_dwordx4 v4, s[40:43], s62 offen offset:1024 sc1 lds
  buffer_load_dwordx4 v4, s[40:43], s62 offen offset:2048 sc1 lds
L_ho_87:
  v_mfma_f32_32x32x16_bf16 v[32:47], v[68:71], v[188:191], v[32:47]
  ds_read_b64_tr_b16 v[92:93], v100 offset:64
  ds_read_b64_tr_b16 v[94:95], v100 offset:832
  v_mfma_f32_32x32x16_bf16 v[48:63], v[72:75], v[188:191], v[48:63]
  ds_read_b64_tr_b16 v[96:97], v100 offset:128
  ds_read_b64_tr_b16 v[98:99], v100 offset:896
  s_waitcnt lgkmcnt(6)
  v_mfma_f32_32x32x16_bf16 v[16:31], v[76:79], v[192:195], v[16:31]
  ds_read_b64_tr_b16 v[64:65], v100 offset:3072
  ds_read_b64_tr_b16 v[66:67], v100 offset:3840
  s_cmp_lt_u32 s46, 4
  s_cbranch_scc1 L_ho_88
  s_lshl_b32 s97, s46, 10
  s_add_u32 m0, s97, 16384
  s_mov_b32 s97, 196608
  buffer_load_dwordx4 v104, s[28:31], s97 offen lds
  s_lshl_b32 s97, s46, 10
  s_add_u32 m0, s97, 24576
  s_mov_b32 s97, 262144
  buffer_load_dwordx4 v104, s[28:31], s97 offen lds
  s_lshl_b32 s97, s46, 10
  s_add_u32 m0, s97, 32768
  s_mov_b32 s97, 327680
  buffer_load_dwordx4 v104, s[28:31], s97 offen lds
  s_add_u32 m0, s59, 73728
  s_add_u32 s62, s63, 79872
  buffer_load_dwordx4 v4, s[40:43], s62 offen offset:0 sc1 lds
  buffer_load_dwordx4 v4, s[40:43], s62 offen offset:1024 sc1 lds
  buffer_load_dwordx4 v4, s[40:43], s62 offen offset:2048 sc1 lds
L_ho_88:
  v_mfma_f32_32x32x16_bf16 v[32:47], v[80:83], v[192:195], v[32:47]
  ds_read_b64_tr_b16 v[68:69], v100 offset:3136
  ds_read_b64_tr_b16 v[70:71], v100 offset:3904
  v_mfma_f32_32x32x16_bf16 v[48:63], v[84:87], v[192:195], v[48:63]
  ds_read_b64_tr_b16 v[72:73], v100 offset:3200
  ds_read_b64_tr_b16 v[74:75], v100 offset:3968
  s_waitcnt vmcnt(9)
  s_barrier
  s_waitcnt lgkmcnt(6)
  v_mfma_f32_32x32x16_bf16 v[16:31], v[88:91], v[196:199], v[16:31]
  ds_read_b64_tr_b16 v[76:77], v100 offset:24576
  ds_read_b64_tr_b16 v[78:79], v100 offset:25344
  s_cmp_ge_u32 s46, 4
  s_cbranch_scc1 L_ho_89
  s_add_u32 m0, s59, 98304
  s_add_u32 s62, s63, 86016
  buffer_load_dwordx4 v4, s[40:43], s62 offen offset:0 sc1 lds
  buffer_load_dwordx4 v4, s[40:43], s62 offen offset:1024 sc1 lds
  buffer_load_dwordx4 v4, s[40:43], s62 offen offset:2048 sc1 lds
L_ho_89:
  ds_read_b64_tr_b16 v[80:81], v100 offset:24640
  v_mfma_f32_32x32x16_bf16 v[32:47], v[92:95], v[196:199], v[32:47]
  ds_read_b64_tr_b16 v[82:83], v100 offset:25408
  ds_read_b64_tr_b16 v[84:85], v100 offset:24704
  ds_read_b64_tr_b16 v[86:87], v100 offset:25472
  s_add_u32 s64, s60, 1
  s_and_b32 s64, s64, 3
  v_mfma_f32_32x32x16_bf16 v[48:63], v[96:99], v[196:199], v[48:63]
  s_lshl_b32 s64, s64, 1
  s_add_u32 s64, s64, s61
  s_mul_i32 s64, s64, 9216
  s_add_u32 s64, s64, 6144
  s_add_u32 s64, s64, 65536
  v_add_u32_e64 v12, s64, v4
  s_add_u32 s64, s60, 2
  s_and_b32 s64, s64, 3
  s_waitcnt lgkmcnt(6)
  v_mfma_f32_32x32x16_bf16 v[16:31], v[64:67], v[200:203], v[16:31]
  ds_read_b64_tr_b16 v[88:89], v100 offset:27648
  ds_read_b64_tr_b16 v[90:91], v100 offset:28416
  s_cmp_lt_u32 s46, 4
  s_cbranch_scc1 L_ho_90
  s_add_u32 m0, s59, 98304
  s_add_u32 s62, s63, 86016
  buffer_load_dwordx4 v4, s[40:43], s62 offen offset:0 sc1 lds
  buffer_load_dwordx4 v4, s[40:43], s62 offen offset:1024 sc1 lds
  buffer_load_dwordx4 v4, s[40:43], s62 offen offset:2048 sc1 lds
L_ho_90:
  ds_read_b64_tr_b16 v[92:93], v100 offset:27712
  v_mfma_f32_32x32x16_bf16 v[32:47], v[68:71], v[200:203], v[32:47]
  ds_read_b64_tr_b16 v[94:95], v100 offset:28480
  ds_read_b64_tr_b16 v[96:97], v100 offset:27776
  ds_read_b64_tr_b16 v[98:99], v100 offset:28544
  s_lshl_b32 s64, s64, 1
  s_add_u32 s64, s64, s61
  v_mfma_f32_32x32x16_bf16 v[48:63], v[72:75], v[200:203], v[48:63]
  s_mul_i32 s64, s64, 9216
  s_add_u32 s64, s64, 3072
  s_add_u32 s64, s64, 65536
  v_add_u32 v13, s64, v4
  s_add_u32 s64, s60, 3
  s_and_b32 s64, s64, 3
  s_lshl_b32 s64, s64, 1
  s_add_u32 s64, s64, s61
  s_waitcnt vmcnt(9)
  s_barrier
  s_waitcnt lgkmcnt(6)
  v_mfma_f32_32x32x16_bf16 v[16:31], v[76:79], v[204:207], v[16:31]
  ds_read_b64_tr_b16 v[64:65], v101 offset:0
  ds_read_b64_tr_b16 v[66:67], v101 offset:768
  s_cmp_ge_u32 s46, 4
  s_cbranch_scc1 L_ho_91
  s_add_u32 m0, s59, 0
  s_add_u32 s62, s63, 92160
  buffer_load_dwordx4 v4, s[40:43], s62 offen offset:0 sc1 lds
  buffer_load_dwordx4 v4, s[40:43], s62 offen offset:1024 sc1 lds
  buffer_load_dwordx4 v4, s[40:43], s62 offen offset:2048 sc1 lds
L_ho_91:
  ds_read_b64_tr_b16 v[68:69], v101 offset:64
  v_mfma_f32_32x32x16_bf16 v[32:47], v[80:83], v[204:207], v[32:47]
  ds_read_b64_tr_b16 v[70:71], v101 offset:832
  ds_read_b64_tr_b16 v[72:73], v101 offset:128
  ds_read_b64_tr_b16 v[74:75], v101 offset:896
  s_mul_i32 s64, s64, 9216
  s_add_u32 s64, s64, 0
  v_mfma_f32_32x32x16_bf16 v[48:63], v[84:87], v[204:207], v[48:63]
  s_add_u32 s64, s64, 65536
  v_add_u32 v14, s64, v4
  v_and_b32 v5, 31, v1
  v_lshrrev_b32_e64 v6, 5, v1
  v_mul_u32_u24 v8, 208, v5
  v_lshl_add_u32 v8, v6, 3, v8
  s_mul_i32 s64, s61, 6656
  s_lshl_b32 s65, s60, 4
  s_waitcnt lgkmcnt(6)
  v_mfma_f32_32x32x16_bf16 v[16:31], v[88:91], v[208:211], v[16:31]
  ds_read_b64_tr_b16 v[76:77], v101 offset:3072
  ds_read_b64_tr_b16 v[78:79], v101 offset:3840
  s_cmp_lt_u32 s46, 4
  s_cbranch_scc1 L_ho_92
  s_add_u32 m0, s59, 0
  s_add_u32 s62, s63, 92160
  buffer_load_dwordx4 v4, s[40:43], s62 offen offset:0 sc1 lds
  buffer_load_dwordx4 v4, s[40:43], s62 offen offset:1024 sc1 lds
  buffer_load_dwordx4 v4, s[40:43], s62 offen offset:2048 sc1 lds
L_ho_92:
  ds_read_b64_tr_b16 v[80:81], v101 offset:3136
  v_mfma_f32_32x32x16_bf16 v[32:47], v[92:95], v[208:211], v[32:47]
  ds_read_b64_tr_b16 v[82:83], v101 offset:3904
  ds_read_b64_tr_b16 v[84:85], v101 offset:3200
  ds_read_b64_tr_b16 v[86:87], v101 offset:3968
  s_add_u32 s64, s64, s65
  v_add_u32_e64 v8, s64, v8
  v_mfma_f32_32x32x16_bf16 v[48:63], v[96:99], v[208:211], v[48:63]
  v_bfe_u32 v7, v1, 4, 1
  v_mul_u32_u24 v9, 22528, v7
  v_lshl_add_u32 v9, v6, 8, v9
  v_and_b32_e64 v5, 15, v1
  v_lshl_add_u32 v9, v5, 4, v9
  s_mul_i32 s64, s46, 9216
  s_add_u32 s64, s64, 0
  s_add_u32 s64, s64, 65536
  s_waitcnt vmcnt(6)
  s_barrier
  s_waitcnt lgkmcnt(6)
  v_mfma_f32_32x32x16_bf16 v[16:31], v[64:67], v[212:215], v[16:31]
  ds_read_b64_tr_b16 v[164:165], v105 offset:16384
  ds_read_b64_tr_b16 v[166:167], v105 offset:17408
  ds_read_b64_tr_b16 v[168:169], v106 offset:16384
  ds_read_b64_tr_b16 v[170:171], v106 offset:17408
  ds_read_b64_tr_b16 v[172:173], v105 offset:20480
  v_mfma_f32_32x32x16_bf16 v[32:47], v[68:71], v[212:215], v[32:47]
  ds_read_b64_tr_b16 v[174:175], v105 offset:21504
  ds_read_b64_tr_b16 v[88:89], v101 offset:24576
  ds_read_b64_tr_b16 v[90:91], v101 offset:25344
  ds_read_b64_tr_b16 v[92:93], v101 offset:24640
  ds_read_b64_tr_b16 v[94:95], v101 offset:25408
  ds_read_b64_tr_b16 v[96:97], v101 offset:24704
  v_mfma_f32_32x32x16_bf16 v[48:63], v[72:75], v[212:215], v[48:63]
  ds_read_b64_tr_b16 v[98:99], v101 offset:25472
  v_add_u32_e64 v10, s64, v4
  s_mul_i32 s64, s46, 9216
  s_add_u32 s64, s64, 3072
  s_add_u32 s64, s64, 65536
  v_add_u32_e64 v11, s64, v4
  s_mul_i32 s64, s46, 9216
  s_add_u32 s64, s64, 6144
  s_add_u32 s64, s64, 65536
  v_add_u32 v15, s64, v4
  v_lshlrev_b32_e64 v103, 16, v103
  s_waitcnt lgkmcnt(12)
  v_mfma_f32_32x32x16_bf16 v[16:31], v[76:79], v[216:219], v[16:31]
  ds_read_b64_tr_b16 v[176:177], v106 offset:20480
  ds_read_b64_tr_b16 v[178:179], v106 offset:21504
  ds_read_b64_tr_b16 v[180:181], v105 offset:24576
  ds_read_b64_tr_b16 v[182:183], v105 offset:25600
  ds_read_b64_tr_b16 v[184:185], v106 offset:24576
  v_mfma_f32_32x32x16_bf16 v[32:47], v[80:83], v[216:219], v[32:47]
  ds_read_b64_tr_b16 v[186:187], v106 offset:25600
  ds_read_b64_tr_b16 v[64:65], v101 offset:27648
  ds_read_b64_tr_b16 v[66:67], v101 offset:28416
  ds_read_b64_tr_b16 v[68:69], v101 offset:27712
  ds_read_b64_tr_b16 v[70:71], v101 offset:28480
  ds_read_b64_tr_b16 v[72:73], v101 offset:27776
  v_mfma_f32_32x32x16_bf16 v[48:63], v[84:87], v[216:219], v[48:63]
  ds_read_b64_tr_b16 v[74:75], v101 offset:28544
  s_lshl_b32 s64, s48, 1
  s_add_u32 s64, s64, s61
  s_mul_i32 s64, s64, 45056
  s_add_u32 s64, s64, s101
  s_lshr_b32 s65, s60, 1
  s_add_u32 s65, s65, s52
  s_lshl_b32 s65, s65, 9
  s_add_u32 s64, s64, s65
  s_and_b32 s65, s60, 1
  s_lshl_b32 s65, s65, 3
  s_waitcnt vmcnt(3)
  s_barrier
  s_waitcnt lgkmcnt(12)
  v_mfma_f32_32x32x16_bf16 v[16:31], v[88:91], v[220:223], v[16:31]
  ds_read_b64_tr_b16 v[188:189], v105 offset:28672
  ds_read_b64_tr_b16 v[190:191], v105 offset:29696
  ds_read_b64_tr_b16 v[192:193], v106 offset:28672
  ds_read_b64_tr_b16 v[194:195], v106 offset:29696
  ds_read_b64_tr_b16 v[196:197], v105 offset:32768
  v_mfma_f32_32x32x16_bf16 v[32:47], v[92:95], v[220:223], v[32:47]
  ds_read_b64_tr_b16 v[198:199], v105 offset:33792
  ds_read_b64_tr_b16 v[76:77], v102 offset:0
  ds_read_b64_tr_b16 v[78:79], v102 offset:768
  ds_read_b64_tr_b16 v[80:81], v102 offset:64
  ds_read_b64_tr_b16 v[82:83], v102 offset:832
  ds_read_b64_tr_b16 v[84:85], v102 offset:128
  v_mfma_f32_32x32x16_bf16 v[48:63], v[96:99], v[220:223], v[48:63]
  ds_read_b64_tr_b16 v[86:87], v102 offset:896
  s_add_u32 s64, s64, s65
  s_add_u32 s68, s64, 262144
  s_add_u32 s69, s68, 1024
  s_add_u32 s70, s68, 2048
  s_lshr_b32 s71, s60, 1
  s_xor_b32 s71, s71, 1
  s_or_b32 s71, s71, s53
  s_cmp_eq_u32 s71, 0
  s_cselect_b32 s70, 0x7ffff000, s70
  s_waitcnt lgkmcnt(12)
  v_mfma_f32_32x32x16_bf16 v[16:31], v[64:67], v[224:227], v[16:31]
  ds_read_b64_tr_b16 v[200:201], v106 offset:32768
  ds_read_b64_tr_b16 v[202:203], v106 offset:33792
  ds_read_b64_tr_b16 v[204:205], v105 offset:36864
  ds_read_b64_tr_b16 v[206:207], v105 offset:37888
  v_mfma_f32_32x32x16_bf16 v[32:47], v[68:71], v[224:227], v[32:47]
  ds_read_b64_tr_b16 v[208:209], v106 offset:36864
  ds_read_b64_tr_b16 v[210:211], v106 offset:37888
  ds_read_b64_tr_b16 v[88:89], v102 offset:3072
  ds_read_b64_tr_b16 v[90:91], v102 offset:3840
  v_mfma_f32_32x32x16_bf16 v[48:63], v[72:75], v[224:227], v[48:63]
  ds_read_b64_tr_b16 v[92:93], v102 offset:3136
  ds_read_b64_tr_b16 v[94:95], v102 offset:3904
  ds_read_b64_tr_b16 v[96:97], v102 offset:3200
  ds_read_b64_tr_b16 v[98:99], v102 offset:3968
  s_waitcnt vmcnt(0)
  s_barrier
  ds_read_b64_tr_b16 v[64:65], v100 offset:0
  ds_read_b64_tr_b16 v[66:67], v100 offset:768
  ds_read_b64_tr_b16 v[68:69], v100 offset:3072
  ds_read_b64_tr_b16 v[70:71], v100 offset:3840
  ds_read_b64_tr_b16 v[72:73], v100 offset:64
  ds_read_b64_tr_b16 v[74:75], v100 offset:832
  s_waitcnt lgkmcnt(15)
  v_mfma_f32_32x32x16_bf16 v[16:31], v[76:79], v[228:231], v[16:31]
  s_waitcnt lgkmcnt(6)
  v_mfma_f32_32x32x16_bf16 v[16:31], v[88:91], v[232:235], v[16:31]
  ds_read_b64_tr_b16 v[76:77], v100 offset:3136
  ds_read_b64_tr_b16 v[78:79], v100 offset:3904
  ds_read_b64_tr_b16 v[88:89], v100 offset:128
  ds_read_b64_tr_b16 v[90:91], v100 offset:896
  s_waitcnt lgkmcnt(8)
  v_mfma_f32_32x32x16_bf16 v[16:31], v[64:67], v[236:239], v[16:31]
  s_waitcnt lgkmcnt(6)
  v_mfma_f32_32x32x16_bf16 v[16:31], v[68:71], v[240:243], v[16:31]
  v_mfma_f32_32x32x16_bf16 v[32:47], v[80:83], v[228:231], v[32:47]
  ds_read_b64_tr_b16 v[80:81], v100 offset:3200
  ds_read_b64_tr_b16 v[82:83], v100 offset:3968
  v_mfma_f32_32x32x16_bf16 v[32:47], v[92:95], v[232:235], v[32:47]
  s_waitcnt lgkmcnt(6)
  v_mfma_f32_32x32x16_bf16 v[32:47], v[72:75], v[236:239], v[32:47]
  s_waitcnt lgkmcnt(4)
  v_mfma_f32_32x32x16_bf16 v[32:47], v[76:79], v[240:243], v[32:47]
  s_nop 3
  ds_write_b128 v12, v[20:23] offset:0
  v_mfma_f32_32x32x16_bf16 v[48:63], v[84:87], v[228:231], v[48:63]
  ds_write_b128 v13, v[24:27] offset:0
  v_mfma_f32_32x32x16_bf16 v[48:63], v[96:99], v[232:235], v[48:63]
  ds_write_b128 v14, v[28:31] offset:0
  s_waitcnt lgkmcnt(5)
  v_mfma_f32_32x32x16_bf16 v[48:63], v[88:91], v[236:239], v[48:63]
  s_waitcnt lgkmcnt(3)
  v_mfma_f32_32x32x16_bf16 v[48:63], v[80:83], v[240:243], v[48:63]
  ds_write_b128 v12, v[36:39] offset:1024
  ds_write_b128 v13, v[40:43] offset:1024
  ds_write_b128 v14, v[44:47] offset:1024
  s_nop 8
  ds_write_b128 v12, v[52:55] offset:2048
  ds_write_b128 v13, v[56:59] offset:2048
  ds_write_b128 v14, v[60:63] offset:2048
  ds_read_b64 v[64:65], v8 offset:0
  ds_read_b64 v[66:67], v8 offset:64
  ds_read_b64 v[68:69], v8 offset:128
  s_waitcnt lgkmcnt(0)
  s_barrier
  ds_read_b128 v[20:23], v10 offset:0
  ds_read_b128 v[36:39], v10 offset:1024
  ds_read_b128 v[52:55], v10 offset:2048
  ds_read_b128 v[24:27], v11 offset:0
  ds_read_b128 v[40:43], v11 offset:1024
  ds_read_b128 v[56:59], v11 offset:2048
  ds_read_b128 v[28:31], v15 offset:0
  ds_read_b128 v[44:47], v15 offset:1024
  ds_read_b128 v[60:63], v15 offset:2048
  v_lshlrev_b32 v72, 16, v64
  v_and_b32 v73, s55, v64
  v_lshlrev_b32 v74, 16, v65
  v_and_b32 v75, s55, v65
  v_lshlrev_b32 v76, 16, v66
  v_and_b32 v77, s55, v66
  v_lshlrev_b32 v78, 16, v67
  v_and_b32 v79, s55, v67
  v_lshlrev_b32 v80, 16, v68
  v_and_b32 v81, s55, v68
  v_lshlrev_b32 v82, 16, v69
  v_and_b32 v83, s55, v69
  v_add_f32 v16, v16, v103
  v_add_f32 v17, v17, v103
  v_add_f32 v18, v18, v103
  v_add_f32 v19, v19, v103
  v_add_f32 v32, v32, v103
  v_add_f32 v33, v33, v103
  v_add_f32 v34, v34, v103
  v_add_f32 v35, v35, v103
  v_add_f32 v48, v48, v103
  v_add_f32 v49, v49, v103
  v_add_f32 v50, v50, v103
  v_add_f32_e64 v51, v51, v103
  s_waitcnt lgkmcnt(6)
  v_pk_add_f32 v[16:17], v[16:17], v[20:21]
  v_pk_add_f32 v[18:19], v[18:19], v[22:23]
  v_pk_add_f32 v[32:33], v[32:33], v[36:37]
  v_pk_add_f32 v[34:35], v[34:35], v[38:39]
  v_pk_add_f32 v[48:49], v[48:49], v[52:53]
  v_pk_add_f32 v[50:51], v[50:51], v[54:55]
  s_waitcnt lgkmcnt(3)
  v_pk_add_f32 v[16:17], v[16:17], v[24:25]
  v_pk_add_f32 v[18:19], v[18:19], v[26:27]
  v_pk_add_f32 v[32:33], v[32:33], v[40:41]
  v_pk_add_f32 v[34:35], v[34:35], v[42:43]
  v_pk_add_f32 v[48:49], v[48:49], v[56:57]
  v_pk_add_f32 v[50:51], v[50:51], v[58:59]
  s_waitcnt lgkmcnt(0)
  v_pk_add_f32 v[16:17], v[16:17], v[28:29]
  v_pk_add_f32 v[18:19], v[18:19], v[30:31]
  v_pk_add_f32 v[32:33], v[32:33], v[44:45]
  v_pk_add_f32 v[34:35], v[34:35], v[46:47]
  v_pk_add_f32 v[48:49], v[48:49], v[60:61]
  v_pk_add_f32 v[50:51], v[50:51], v[62:63]
  v_pk_mul_f32 v[16:17], v[16:17], v[72:73]
  v_pk_mul_f32 v[18:19], v[18:19], v[74:75]
  v_cvt_pk_bf16_f32 v84, v16, v17
  v_cvt_pk_bf16_f32 v85, v18, v19
  buffer_store_dwordx2 v[84:85], v9, s[40:43], s68 offen
  v_pk_mul_f32 v[32:33], v[32:33], v[76:77]
  v_pk_mul_f32 v[34:35], v[34:35], v[78:79]
  v_cvt_pk_bf16_f32 v86, v32, v33
  v_cvt_pk_bf16_f32 v87, v34, v35
  buffer_store_dwordx2 v[86:87], v9, s[40:43], s69 offen
  v_pk_mul_f32 v[48:49], v[48:49], v[80:81]
  v_pk_mul_f32 v[50:51], v[50:51], v[82:83]
  v_cvt_pk_bf16_f32 v88, v48, v49
  v_cvt_pk_bf16_f32 v89, v50, v51
  buffer_store_dwordx2 v[88:89], v9, s[40:43], s70 offen
  s_lshl_b32 s56, s46, 10
  s_and_b32 s72, s46, 3
  s_lshl_b32 s72, s72, 11
  v_add_u32 v109, s72, v4
  v_add_u32 v110, 65536, v109
  v_add_u32 v113, 131072, v109
  s_lshl_b32 s57, s48, 2
  s_lshr_b32 s72, s46, 1
  s_add_u32 s57, s57, s72
  s_mul_i32 s57, s57, 22528
  s_and_b32 s72, s46, 1
  s_lshl_b32 s73, s72, 10
  s_add_u32 s57, s57, s73
  s_add_u32 s57, s57, s101
  s_add_u32 s57, s57, 262144
  s_mul_i32 s72, s72, 0x7f000000
  v_lshrrev_b32 v5, 5, v1
  v_mul_lo_u32 v5, v5, s72
  v_add_u32 v111, v5, v4
  v_and_b32 v5, 15, v1
  v_lshlrev_b32_e64 v5, 10, v5
  v_bfe_u32 v6, v1, 4, 1
  v_lshl_add_u32 v5, v6, 5, v5
  v_lshrrev_b32_e64 v6, 5, v1
  v_lshl_add_u32 v112, v6, 4, v5
  s_and_b32 s72, s46, 3
  s_lshl_b32 s72, s72, 14
  s_lshl_b32 s73, s50, 16
  s_add_u32 s72, s72, s73
  s_lshl_b32 s73, s49, 7
  s_add_u32 s72, s72, s73
  s_lshr_b32 s73, s46, 2
  s_lshl_b32 s73, s73, 6
  s_add_u32 s58, s72, s73
  s_waitcnt vmcnt(0)
  s_waitcnt lgkmcnt(0)
  s_barrier
  s_cmp_lg_u32 s46, 0
  s_cbranch_scc1 L_w0_93
  s_mov_b64 exec, 0x10
  s_cmp_eq_u32 s47, 0
  s_cbranch_scc1 L_sigw_94
  buffer_store_dword v3, v2, s[40:43], 0 offen
  s_branch L_sigd_95
L_sigw_94:
  buffer_wbl2 sc1
  s_waitcnt vmcnt(0)
  buffer_store_dword v3, v2, s[40:43], 0 offen sc1
L_sigd_95:
  s_mov_b64 exec, -1
L_w0_93:
  s_lshl_b32 s97, s46, 10
  s_add_u32 m0, s97, 16384
  s_mov_b32 s97, 393216
  buffer_load_dwordx4 v104, s[28:31], s97 offen lds
  s_lshl_b32 s97, s46, 10
  s_add_u32 m0, s97, 24576
  s_mov_b32 s97, 458752
  buffer_load_dwordx4 v104, s[28:31], s97 offen lds
  s_lshl_b32 s97, s46, 10
  s_add_u32 m0, s97, 32768
  s_mov_b32 s97, 524288
  buffer_load_dwordx4 v104, s[28:31], s97 offen lds
  s_lshl_b32 s97, s46, 10
  s_add_u32 m0, s97, 40960
  s_mov_b32 s97, 589824
  buffer_load_dwordx4 v104, s[28:31], s97 offen lds
  s_lshl_b32 s97, s46, 10
  s_add_u32 m0, s97, 49152
  s_mov_b32 s97, 655360
  buffer_load_dwordx4 v104, s[28:31], s97 offen lds
  s_waitcnt vmcnt(0)
  s_cmp_lg_u32 s46, 0
  s_cbranch_scc1 L_w0_96
  s_lshl_b32 s96, s50, 7
  s_add_u32 s96, s96, 20480
  v_lshlrev_b32 v5, 2, v1
  s_mov_b64 exec, 0xff
  s_mov_b32 s3, 131072
L_poll_97:
  buffer_load_dword v6, v5, s[40:43], s96 offen sc1
  s_waitcnt vmcnt(0)
  v_cmp_ne_u32 vcc, v6, v3
  s_cbranch_vccz L_pok_98
  s_sub_u32 s3, s3, 1
  s_cmp_lg_u32 s3, 0
  s_cbranch_scc1 L_poll_97
L_pok_98:
  s_mov_b64 exec, -1
  s_cmp_lg_u32 s47, 0
  s_cbranch_scc1 L_acq_99
  buffer_inv sc1
  s_waitcnt vmcnt(0)
L_acq_99:
L_w0_96:
  s_barrier
  s_add_u32 m0, s56, 57344
  s_add_u32 s97, s57, 0
  buffer_load_dwordx4 v4, s[40:43], s97 offen sc1 lds
  s_add_u32 m0, s56, 65536
  s_add_u32 s97, s57, 2048
  buffer_load_dwordx4 v4, s[40:43], s97 offen sc1 lds
  s_add_u32 m0, s56, 73728
  s_add_u32 s97, s57, 4096
  buffer_load_dwordx4 v4, s[40:43], s97 offen sc1 lds
  s_barrier
  s_add_u32 m0, s56, 81920
  s_add_u32 s97, s57, 6144
  buffer_load_dwordx4 v4, s[40:43], s97 offen sc1 lds
  ds_read_b64_tr_b16 v[212:213], v105 offset:16384
  ds_read_b64_tr_b16 v[214:215], v105 offset:17408
  ds_read_b64_tr_b16 v[216:217], v106 offset:16384
  ds_read_b64_tr_b16 v[218:219], v106 offset:17408
  s_add_u32 m0, s56, 90112
  s_add_u32 s97, s57, 8192
  buffer_load_dwordx4 v4, s[40:43], s97 offen sc1 lds
  ds_read_b64_tr_b16 v[220:221], v105 offset:20480
  ds_read_b64_tr_b16 v[222:223], v105 offset:21504
  ds_read_b64_tr_b16 v[224:225], v106 offset:20480
  ds_read_b64_tr_b16 v[226:227], v106 offset:21504
  s_add_u32 m0, s56, 98304
  s_add_u32 s97, s57, 10240
  buffer_load_dwordx4 v4, s[40:43], s97 offen sc1 lds
  ds_read_b64_tr_b16 v[228:229], v105 offset:24576
  ds_read_b64_tr_b16 v[230:231], v105 offset:25600
  ds_read_b64_tr_b16 v[232:233], v106 offset:24576
  ds_read_b64_tr_b16 v[234:235], v106 offset:25600
  s_barrier
  s_add_u32 m0, s56, 106496
  s_add_u32 s97, s57, 12288
  buffer_load_dwordx4 v4, s[40:43], s97 offen sc1 lds
  ds_read_b64_tr_b16 v[236:237], v105 offset:28672
  ds_read_b64_tr_b16 v[238:239], v105 offset:29696
  ds_read_b64_tr_b16 v[240:241], v106 offset:28672
  ds_read_b64_tr_b16 v[242:243], v106 offset:29696
  ds_read_b64_tr_b16 v[40:41], v105 offset:32768
  ds_read_b64_tr_b16 v[42:43], v105 offset:33792
  s_add_u32 m0, s56, 114688
  s_add_u32 s97, s57, 14336
  buffer_load_dwordx4 v4, s[40:43], s97 offen sc1 lds
  ds_read_b64_tr_b16 v[44:45], v106 offset:32768
  ds_read_b64_tr_b16 v[46:47], v106 offset:33792
  ds_read_b64_tr_b16 v[48:49], v105 offset:36864
  ds_read_b64_tr_b16 v[50:51], v105 offset:37888
  ds_read_b64_tr_b16 v[52:53], v106 offset:36864
  ds_read_b64_tr_b16 v[54:55], v106 offset:37888
  s_add_u32 m0, s56, 122880
  s_add_u32 s97, s57, 16384
  buffer_load_dwordx4 v4, s[40:43], s97 offen sc1 lds
  ds_read_b64_tr_b16 v[56:57], v105 offset:40960
  ds_read_b64_tr_b16 v[58:59], v105 offset:41984
  ds_read_b64_tr_b16 v[60:61], v106 offset:40960
  ds_read_b64_tr_b16 v[62:63], v106 offset:41984
  ds_read_b64_tr_b16 v[64:65], v105 offset:45056
  s_add_u32 m0, s56, 131072
  s_add_u32 s97, s57, 18432
  buffer_load_dwordx4 v4, s[40:43], s97 offen sc1 lds
  ds_read_b64_tr_b16 v[66:67], v105 offset:46080
  ds_read_b64_tr_b16 v[68:69], v106 offset:45056
  ds_read_b64_tr_b16 v[70:71], v106 offset:46080
  ds_read_b64_tr_b16 v[72:73], v105 offset:49152
  ds_read_b64_tr_b16 v[74:75], v105 offset:50176
  ds_read_b64_tr_b16 v[76:77], v106 offset:49152
  s_add_u32 m0, s56, 139264
  s_add_u32 s97, s57, 20480
  buffer_load_dwordx4 v111, s[40:43], s97 offen sc1 lds
  ds_read_b64_tr_b16 v[78:79], v106 offset:50176
  ds_read_b64_tr_b16 v[80:81], v105 offset:53248
  ds_read_b64_tr_b16 v[82:83], v105 offset:54272
  ds_read_b64_tr_b16 v[84:85], v106 offset:53248
  ds_read_b64_tr_b16 v[86:87], v106 offset:54272
  s_waitcnt vmcnt(8)
  s_barrier
  ds_read_b128 v[24:27], v109 offset:57344
  ds_read_b128 v[28:31], v109 offset:58368
  ds_read_b128 v[32:35], v110 offset:0
  s_waitcnt lgkmcnt(2)
  v_mfma_f32_16x16x32_bf16 v[16:19], v[116:119], v[24:27], 0
  ds_read_b128 v[36:39], v110 offset:1024
  v_mfma_f32_16x16x32_bf16 v[20:23], v[120:123], v[24:27], 0
  s_waitcnt lgkmcnt(2)
  v_mfma_f32_16x16x32_bf16 v[16:19], v[124:127], v[28:31], v[16:19]
  ds_read_b128 v[24:27], v110 offset:8192
  v_mfma_f32_16x16x32_bf16 v[20:23], v[128:131], v[28:31], v[20:23]
  s_waitcnt vmcnt(5)
  s_barrier
  s_waitcnt lgkmcnt(2)
  v_mfma_f32_16x16x32_bf16 v[16:19], v[132:135], v[32:35], v[16:19]
  ds_read_b128 v[28:31], v110 offset:9216
  v_mfma_f32_16x16x32_bf16 v[20:23], v[136:139], v[32:35], v[20:23]
  s_waitcnt lgkmcnt(2)
  v_mfma_f32_16x16x32_bf16 v[16:19], v[140:143], v[36:39], v[16:19]
  ds_read_b128 v[32:35], v110 offset:16384
  v_mfma_f32_16x16x32_bf16 v[20:23], v[144:147], v[36:39], v[20:23]
  s_waitcnt lgkmcnt(2)
  v_mfma_f32_16x16x32_bf16 v[16:19], v[148:151], v[24:27], v[16:19]
  ds_read_b128 v[36:39], v110 offset:17408
  v_mfma_f32_16x16x32_bf16 v[20:23], v[152:155], v[24:27], v[20:23]
  s_waitcnt lgkmcnt(2)
  v_mfma_f32_16x16x32_bf16 v[16:19], v[156:159], v[28:31], v[16:19]
  ds_read_b128 v[24:27], v110 offset:24576
  v_mfma_f32_16x16x32_bf16 v[20:23], v[160:163], v[28:31], v[20:23]
  s_waitcnt lgkmcnt(2)
  v_mfma_f32_16x16x32_bf16 v[16:19], v[164:167], v[32:35], v[16:19]
  ds_read_b128 v[28:31], v110 offset:25600
  v_mfma_f32_16x16x32_bf16 v[20:23], v[168:171], v[32:35], v[20:23]
  s_waitcnt lgkmcnt(2)
  v_mfma_f32_16x16x32_bf16 v[16:19], v[172:175], v[36:39], v[16:19]
  ds_read_b128 v[32:35], v110 offset:32768
  v_mfma_f32_16x16x32_bf16 v[20:23], v[176:179], v[36:39], v[20:23]
  s_waitcnt vmcnt(0)
  s_barrier
  s_lshl_b32 s64, s45, 3
  s_add_u32 s64, s64, s46
  s_cmp_lg_u32 s64, 7
  s_cbranch_scc1 L_wb_100
  buffer_wbl2 sc1
L_wb_100:
  s_waitcnt lgkmcnt(2)
  v_mfma_f32_16x16x32_bf16 v[16:19], v[180:183], v[24:27], v[16:19]
  ds_read_b128 v[36:39], v110 offset:33792
  v_mfma_f32_16x16x32_bf16 v[20:23], v[184:187], v[24:27], v[20:23]
  s_waitcnt lgkmcnt(2)
  v_mfma_f32_16x16x32_bf16 v[16:19], v[188:191], v[28:31], v[16:19]
  ds_read_b128 v[24:27], v110 offset:40960
  v_mfma_f32_16x16x32_bf16 v[20:23], v[192:195], v[28:31], v[20:23]
  s_waitcnt lgkmcnt(2)
  v_mfma_f32_16x16x32_bf16 v[16:19], v[196:199], v[32:35], v[16:19]
  ds_read_b128 v[28:31], v110 offset:41984
  v_mfma_f32_16x16x32_bf16 v[20:23], v[200:203], v[32:35], v[20:23]
  s_waitcnt lgkmcnt(2)
  v_mfma_f32_16x16x32_bf16 v[16:19], v[204:207], v[36:39], v[16:19]
  ds_read_b128 v[32:35], v110 offset:49152
  v_mfma_f32_16x16x32_bf16 v[20:23], v[208:211], v[36:39], v[20:23]
  s_waitcnt lgkmcnt(2)
  v_mfma_f32_16x16x32_bf16 v[16:19], v[212:215], v[24:27], v[16:19]
  ds_read_b128 v[36:39], v110 offset:50176
  v_mfma_f32_16x16x32_bf16 v[20:23], v[216:219], v[24:27], v[20:23]
  s_waitcnt lgkmcnt(2)
  v_mfma_f32_16x16x32_bf16 v[16:19], v[220:223], v[28:31], v[16:19]
  ds_read_b128 v[24:27], v110 offset:57344
  v_mfma_f32_16x16x32_bf16 v[20:23], v[224:227], v[28:31], v[20:23]
  s_waitcnt lgkmcnt(2)
  v_mfma_f32_16x16x32_bf16 v[16:19], v[228:231], v[32:35], v[16:19]
  ds_read_b128 v[28:31], v110 offset:58368
  v_mfma_f32_16x16x32_bf16 v[20:23], v[232:235], v[32:35], v[20:23]
  s_waitcnt lgkmcnt(2)
  v_mfma_f32_16x16x32_bf16 v[16:19], v[236:239], v[36:39], v[16:19]
  ds_read_b128 v[32:35], v113 offset:0
  v_mfma_f32_16x16x32_bf16 v[20:23], v[240:243], v[36:39], v[20:23]
  s_waitcnt lgkmcnt(2)
  v_mfma_f32_16x16x32_bf16 v[16:19], v[40:43], v[24:27], v[16:19]
  ds_read_b128 v[36:39], v113 offset:1024
  v_mfma_f32_16x16x32_bf16 v[20:23], v[44:47], v[24:27], v[20:23]
  s_waitcnt lgkmcnt(2)
  v_mfma_f32_16x16x32_bf16 v[16:19], v[48:51], v[28:31], v[16:19]
  ds_read_b128 v[24:27], v113 offset:8192
  v_mfma_f32_16x16x32_bf16 v[20:23], v[52:55], v[28:31], v[20:23]
  s_waitcnt lgkmcnt(2)
  v_mfma_f32_16x16x32_bf16 v[16:19], v[56:59], v[32:35], v[16:19]
  ds_read_b128 v[28:31], v113 offset:9216
  v_mfma_f32_16x16x32_bf16 v[20:23], v[60:63], v[32:35], v[20:23]
  s_waitcnt lgkmcnt(2)
  v_mfma_f32_16x16x32_bf16 v[16:19], v[64:67], v[36:39], v[16:19]
  v_mfma_f32_16x16x32_bf16 v[20:23], v[68:71], v[36:39], v[20:23]
  s_waitcnt lgkmcnt(1)
  v_mfma_f32_16x16x32_bf16 v[16:19], v[72:75], v[24:27], v[16:19]
  v_mfma_f32_16x16x32_bf16 v[20:23], v[76:79], v[24:27], v[20:23]
  s_waitcnt lgkmcnt(0)
  v_mfma_f32_16x16x32_bf16 v[16:19], v[80:83], v[28:31], v[16:19]
  v_mfma_f32_16x16x32_bf16 v[20:23], v[84:87], v[28:31], v[20:23]
  s_nop 6
  v_pk_add_f32 v[16:17], v[16:17], v[248:249]
  v_pk_add_f32 v[18:19], v[18:19], v[250:251]
  v_pk_add_f32 v[20:21], v[20:21], v[252:253]
  v_pk_add_f32 v[22:23], v[22:23], v[254:255]
  v_cvt_pk_bf16_f32 v24, v16, v17
  v_cvt_pk_bf16_f32 v25, v18, v19
  v_cvt_pk_bf16_f32 v26, v20, v21
  v_cvt_pk_bf16_f32 v27, v22, v23
  s_nop 0
  v_permlane16_swap_b32 v24, v26
  v_permlane16_swap_b32 v25, v27
  buffer_store_dwordx4 v[24:27], v112, s[32:35], s58 offen
  s_branch L_end
L_att_fallback:
  s_mov_b32 s54, 1
  v_mov_b32 v8, 0xff800000
  v_mov_b32 v9, 0xff800000
  v_mov_b32 v10, 0xff800000
  v_mov_b32 v11, 0xff800000
  s_mov_b32 s72, 0
L_fb_loop:
  s_add_u32 s71, s58, s72
  buffer_load_dwordx4 v[192:195], v4, s[40:43], s71 offen sc1
  s_waitcnt vmcnt(0)
  v_mfma_f32_32x32x16_bf16 v[160:175], v[192:195], v[16:19], 0
  s_nop 11
  v_max3_f32 v8, v160, v161, v8
  v_max3_f32 v8, v162, v163, v8
  v_max3_f32 v8, v164, v165, v8
  v_max3_f32 v8, v166, v167, v8
  v_max3_f32 v8, v168, v169, v8
  v_max3_f32 v8, v170, v171, v8
  v_max3_f32 v8, v172, v173, v8
  v_max3_f32 v8, v174, v175, v8
  s_nop 1
  v_mfma_f32_32x32x16_bf16 v[160:175], v[192:195], v[20:23], 0
  s_nop 11
  v_max3_f32 v9, v160, v161, v9
  v_max3_f32 v9, v162, v163, v9
  v_max3_f32 v9, v164, v165, v9
  v_max3_f32 v9, v166, v167, v9
  v_max3_f32 v9, v168, v169, v9
  v_max3_f32 v9, v170, v171, v9
  v_max3_f32 v9, v172, v173, v9
  v_max3_f32 v9, v174, v175, v9
  s_nop 1
  v_mfma_f32_32x32x16_bf16 v[160:175], v[192:195], v[24:27], 0
  s_nop 11
  v_max3_f32 v10, v160, v161, v10
  v_max3_f32 v10, v162, v163, v10
  v_max3_f32 v10, v164, v165, v10
  v_max3_f32 v10, v166, v167, v10
  v_max3_f32 v10, v168, v169, v10
  v_max3_f32 v10, v170, v171, v10
  v_max3_f32 v10, v172, v173, v10
  v_max3_f32 v10, v174, v175, v10
  s_nop 1
  v_mfma_f32_32x32x16_bf16 v[160:175], v[192:195], v[28:31], 0
  s_nop 11
  v_max3_f32 v11, v160, v161, v11
  v_max3_f32 v11, v162, v163, v11
  v_max3_f32 v11, v164, v165, v11
  v_max3_f32 v11, v166, v167, v11
  v_max3_f32 v11, v168, v169, v11
  v_max3_f32 v11, v170, v171, v11
  v_max3_f32 v11, v172, v173, v11
  v_max3_f32 v11, v174, v175, v11
  s_nop 1
  s_add_u32 s72, s72, 1024
  s_cmp_lt_u32 s72, 16384
  s_cbranch_scc1 L_fb_loop
  v_and_b32 v6, 31, v1
  v_lshlrev_b32 v6, 2, v6
  v_mov_b32 v7, v8
  s_nop 1
  v_permlane32_swap_b32 v8, v7
  v_max_f32 v8, v8, v7
  s_add_u32 s70, s60, 1
  s_and_b32 s70, s70, 3
  s_lshl_b32 s70, s70, 1
  s_and_b32 s71, s46, 1
  s_add_u32 s70, s70, s71
  s_lshl_b32 s70, s70, 9
  s_add_u32 s70, s70, 91136
  v_add_u32 v12, s70, v6
  s_lshl_b32 s71, s60, 7
  v_add_u32_e64 v5, s71, v12
  ds_write_b32 v5, v8
  v_mov_b32 v7, v9
  s_nop 1
  v_permlane32_swap_b32 v9, v7
  v_max_f32 v9, v9, v7
  s_add_u32 s70, s60, 2
  s_and_b32 s70, s70, 3
  s_lshl_b32 s70, s70, 1
  s_and_b32 s71, s46, 1
  s_add_u32 s70, s70, s71
  s_lshl_b32 s70, s70, 9
  s_add_u32 s70, s70, 91136
  v_add_u32 v13, s70, v6
  s_lshl_b32 s71, s60, 7
  v_add_u32_e64 v5, s71, v13
  ds_write_b32 v5, v9
  v_mov_b32 v7, v10
  s_nop 1
  v_permlane32_swap_b32 v10, v7
  v_max_f32 v10, v10, v7
  s_add_u32 s70, s60, 3
  s_and_b32 s70, s70, 3
  s_lshl_b32 s70, s70, 1
  s_and_b32 s71, s46, 1
  s_add_u32 s70, s70, s71
  s_lshl_b32 s70, s70, 9
  s_add_u32 s70, s70, 91136
  v_add_u32 v14, s70, v6
  s_lshl_b32 s71, s60, 7
  v_add_u32_e64 v5, s71, v14
  ds_write_b32 v5, v10
  v_mov_b32 v7, v11
  s_nop 1
  v_permlane32_swap_b32 v11, v7
  v_max_f32 v11, v11, v7
  s_add_u32 s70, s60, 4
  s_and_b32 s70, s70, 3
  s_lshl_b32 s70, s70, 1
  s_and_b32 s71, s46, 1
  s_add_u32 s70, s70, s71
  s_lshl_b32 s70, s70, 9
  s_add_u32 s70, s70, 91136
  v_add_u32 v15, s70, v6
  s_lshl_b32 s71, s60, 7
  v_add_u32_e64 v5, s71, v15
  ds_write_b32 v5, v11
  s_waitcnt lgkmcnt(0)
  s_barrier
  ds_read_b32 v160, v12 offset:0
  ds_read_b32 v161, v12 offset:128
  ds_read_b32 v162, v12 offset:256
  ds_read_b32 v163, v12 offset:384
  s_waitcnt lgkmcnt(0)
  v_max3_f32 v5, v160, v161, v162
  v_max_f32 v5, v5, v163
  v_sub_f32 v5, 0, v5
  v_mov_b32 v32, v5
  v_mov_b32 v33, v5
  v_mov_b32 v34, v5
  v_mov_b32 v35, v5
  v_mov_b32 v36, v5
  v_mov_b32 v37, v5
  v_mov_b32 v38, v5
  v_mov_b32 v39, v5
  v_mov_b32 v40, v5
  v_mov_b32 v41, v5
  v_mov_b32 v42, v5
  v_mov_b32 v43, v5
  v_mov_b32 v44, v5
  v_mov_b32 v45, v5
  v_mov_b32 v46, v5
  v_mov_b32_e64 v47, v5
  ds_read_b32 v160, v13 offset:0
  ds_read_b32 v161, v13 offset:128
  ds_read_b32 v162, v13 offset:256
  ds_read_b32 v163, v13 offset:384
  s_waitcnt lgkmcnt(0)
  v_max3_f32 v5, v160, v161, v162
  v_max_f32 v5, v5, v163
  v_sub_f32 v5, 0, v5
  v_mov_b32 v48, v5
  v_mov_b32 v49, v5
  v_mov_b32 v50, v5
  v_mov_b32 v51, v5
  v_mov_b32 v52, v5
  v_mov_b32 v53, v5
  v_mov_b32 v54, v5
  v_mov_b32 v55, v5
  v_mov_b32 v56, v5
  v_mov_b32 v57, v5
  v_mov_b32 v58, v5
  v_mov_b32 v59, v5
  v_mov_b32 v60, v5
  v_mov_b32 v61, v5
  v_mov_b32 v62, v5
  v_mov_b32_e64 v63, v5
  ds_read_b32 v160, v14 offset:0
  ds_read_b32 v161, v14 offset:128
  ds_read_b32 v162, v14 offset:256
  ds_read_b32 v163, v14 offset:384
  s_waitcnt lgkmcnt(0)
  v_max3_f32 v5, v160, v161, v162
  v_max_f32 v5, v5, v163
  v_sub_f32 v5, 0, v5
  v_mov_b32 v64, v5
  v_mov_b32 v65, v5
  v_mov_b32 v66, v5
  v_mov_b32 v67, v5
  v_mov_b32 v68, v5
  v_mov_b32 v69, v5
  v_mov_b32 v70, v5
  v_mov_b32 v71, v5
  v_mov_b32 v72, v5
  v_mov_b32 v73, v5
  v_mov_b32 v74, v5
  v_mov_b32 v75, v5
  v_mov_b32 v76, v5
  v_mov_b32 v77, v5
  v_mov_b32 v78, v5
  v_mov_b32_e64 v79, v5
  ds_read_b32 v160, v15 offset:0
  ds_read_b32 v161, v15 offset:128
  ds_read_b32 v162, v15 offset:256
  ds_read_b32 v163, v15 offset:384
  s_waitcnt lgkmcnt(0)
  v_max3_f32 v5, v160, v161, v162
  v_max_f32 v5, v5, v163
  v_sub_f32 v5, 0, v5
  v_mov_b32 v80, v5
  v_mov_b32 v81, v5
  v_mov_b32 v82, v5
  v_mov_b32 v83, v5
  v_mov_b32 v84, v5
  v_mov_b32 v85, v5
  v_mov_b32 v86, v5
  v_mov_b32 v87, v5
  v_mov_b32 v88, v5
  v_mov_b32 v89, v5
  v_mov_b32 v90, v5
  v_mov_b32 v91, v5
  v_mov_b32 v92, v5
  v_mov_b32 v93, v5
  v_mov_b32 v94, v5
  v_mov_b32 v95, v5
  v_mov_b32 v184, 0
  v_mov_b32 v185, 0
  v_mov_b32 v186, 0
  v_mov_b32 v187, 0
  s_nop 1
  v_mfma_f32_32x32x16_bf16 v[96:111], v[184:187], v[184:187], 0
  v_mfma_f32_32x32x16_bf16 v[112:127], v[184:187], v[184:187], 0
  v_mfma_f32_32x32x16_bf16 v[128:143], v[184:187], v[184:187], 0
  v_mfma_f32_32x32x16_bf16 v[144:159], v[184:187], v[184:187], 0
  s_add_u32 s64, s59, 0
  s_add_u32 s65, s58, 0
  s_mov_b64 exec, s[98:99]
  buffer_load_dwordx4 v[204:207], v229, s[40:43], s64 offen sc1
  buffer_load_dwordx4 v[208:211], v229, s[40:43], s64 offen offset:512 sc1
  s_mov_b64 exec, -1
  buffer_load_dwordx4 v[192:195], v4, s[40:43], s65 offen sc1
  s_add_u32 s64, s59, 1024
  s_add_u32 s65, s58, 1024
  s_mov_b64 exec, s[98:99]
  buffer_load_dwordx4 v[212:215], v229, s[40:43], s64 offen sc1
  buffer_load_dwordx4 v[216:219], v229, s[40:43], s64 offen offset:512 sc1
  s_mov_b64 exec, -1
  buffer_load_dwordx4 v[196:199], v4, s[40:43], s65 offen sc1
  v_lshlrev_b32 v8, 2, v1
  s_add_u32 s64, s60, 1
  s_and_b32 s64, s64, 3
  s_lshl_b32 s64, s64, 1
  s_and_b32 s65, s46, 1
  s_add_u32 s64, s64, s65
  s_mul_i32 s64, s64, 6912
  s_add_u32 s64, s64, 0
  v_add_u32 v12, s64, v4
  v_add_u32 v5, s64, v8
  s_add_u32 s64, s60, 2
  s_and_b32 s64, s64, 3
  s_lshl_b32 s64, s64, 1
  s_and_b32 s65, s46, 1
  s_add_u32 s64, s64, s65
  s_mul_i32 s64, s64, 6912
  s_add_u32 s64, s64, 2304
  v_add_u32 v13, s64, v4
  v_add_u32_e64 v6, s64, v8
  s_add_u32 s64, s60, 3
  s_and_b32 s64, s64, 3
  s_lshl_b32 s64, s64, 1
  s_and_b32 s65, s46, 1
  s_add_u32 s64, s64, s65
  s_mul_i32 s64, s64, 6912
  s_add_u32 s64, s64, 4608
  v_add_u32 v14, s64, v4
  v_add_u32 v7, s64, v8
  s_mul_i32 s64, s46, 6912
  v_add_u32 v9, s64, v4
  v_and_b32 v10, 31, v1
  v_lshlrev_b32 v10, 2, v10
  v_add_u32 v10, s64, v10
  v_bfe_u32 v11, v1, 4, 1
  v_lshlrev_b32 v11, 14, v11
  v_add_u32_e64 v11, v11, v229
  s_waitcnt vmcnt(3)
  v_mfma_f32_32x32x16_bf16 v[160:175], v[192:195], v[16:19], v[32:47]
  s_setprio 3
  s_nop 10
  v_exp_f32 v160, v160
  v_exp_f32 v161, v161
  v_exp_f32 v162, v162
  v_exp_f32 v163, v163
  v_exp_f32 v164, v164
  v_exp_f32 v165, v165
  v_exp_f32_e64 v166, v166
  v_mfma_f32_32x32x16_bf16 v[176:191], v[192:195], v[20:23], v[48:63]
  v_exp_f32 v167, v167
  v_exp_f32 v168, v168
  v_exp_f32 v169, v169
  v_exp_f32 v170, v170
  v_exp_f32_e64 v171, v171
  v_smfmac_f32_32x32x32_bf16 v[96:111], v[204:207], v[160:167], v228
  v_exp_f32 v172, v172
  v_exp_f32 v173, v173
  v_exp_f32 v174, v174
  v_exp_f32 v175, v175
  v_exp_f32 v176, v176
  v_exp_f32 v177, v177
  v_smfmac_f32_32x32x32_bf16 v[96:111], v[208:211], v[168:175], v228
  v_exp_f32 v178, v178
  v_exp_f32 v179, v179
  v_exp_f32 v180, v180
  v_exp_f32 v181, v181
  v_exp_f32_e64 v182, v182
  v_mfma_f32_32x32x16_bf16 v[160:175], v[192:195], v[24:27], v[64:79]
  v_exp_f32 v183, v183
  v_exp_f32 v184, v184
  v_exp_f32 v185, v185
  v_exp_f32 v186, v186
  v_exp_f32_e64 v187, v187
  v_smfmac_f32_32x32x32_bf16 v[112:127], v[204:207], v[176:183], v228
  v_exp_f32 v188, v188
  v_exp_f32 v189, v189
  v_exp_f32 v190, v190
  v_exp_f32 v191, v191
  v_exp_f32 v160, v160
  v_exp_f32 v161, v161
  v_smfmac_f32_32x32x32_bf16 v[112:127], v[208:211], v[184:191], v228
  v_exp_f32 v162, v162
  v_exp_f32 v163, v163
  v_exp_f32 v164, v164
  v_exp_f32 v165, v165
  v_exp_f32_e64 v166, v166
  v_mfma_f32_32x32x16_bf16 v[176:191], v[192:195], v[28:31], v[80:95]
  v_exp_f32 v167, v167
  v_exp_f32 v168, v168
  v_exp_f32 v169, v169
  v_exp_f32 v170, v170
  v_exp_f32_e64 v171, v171
  v_smfmac_f32_32x32x32_bf16 v[128:143], v[204:207], v[160:167], v228
  v_exp_f32 v172, v172
  v_exp_f32 v173, v173
  v_exp_f32 v174, v174
  v_exp_f32 v175, v175
  s_nop 3
  s_branch L_att_step3
L_end:
  s_endpgm
.fill 64, 4, 0xbf800000
.section .rodata,"a"
.p2align 6
.amdhsa_kernel sequential_preLN__softmax_full_mha__mixer_gmlp__prompt_kernel
  .amdhsa_next_free_vgpr 256
  .amdhsa_next_free_sgpr 102
  .amdhsa_accum_offset 256
  .amdhsa_group_segment_fixed_size 0
  .amdhsa_kernarg_size 88
  .amdhsa_user_sgpr_count 2
  .amdhsa_user_sgpr_kernarg_segment_ptr 1
  .amdhsa_system_sgpr_workgroup_id_x 1
  .amdhsa_float_denorm_mode_32 3
.end_amdhsa_kernel
```
